```python
import torch

def _softmax(x, axis=-1):
    return torch.softmax(x, dim=axis)
def _gelu(x):
    return torch.nn.functional.gelu(x, approximate="tanh")
def _silu(x):
    return torch.nn.functional.silu(x)
def _sigmoid(x):
    return torch.sigmoid(x)
def _layernorm(x, axis=-1, eps=1e-5):
    m = x.mean(dim=axis, keepdim=True)
    v = x.var(dim=axis, keepdim=True, unbiased=False)
    return (x - m) / torch.sqrt(v + eps)
def _scatter_add(tgt, idx, src, axis=0):
    return tgt.clone().index_add_(axis, idx, src)
def _segment_sum(src, seg, n):
    out = torch.zeros((n,) + src.shape[1:], dtype=src.dtype)
    return out.index_add_(0, seg, src)
def _pad(x, pw):
    flat = tuple(v for pair in reversed(pw) for v in pair)
    return torch.nn.functional.pad(x, flat)

kernel_name = 'sequential_preLN__mha_block_cached__glu_gated_reglu__decode'

def setup_inputs():

    _w = (lambda a: (lambda t: t.to(torch.bfloat16) if t.is_floating_point() else t)(torch.as_tensor(a)))
    def _A_setup():
        B, Sq, D = 1, 1, 640
        H, Sk, Dh = 32, 8192, 192
        return {
            "x": _w((lambda *s: torch.randn(*s, dtype=torch.bfloat16) * 0.05)(B, Sq, D)),
            "k_cache": _w((lambda *s: torch.randn(*s, dtype=torch.bfloat16) * 1.6)(B, H, Sk, Dh)),
            "v_cache": _w((lambda *s: torch.randn(*s, dtype=torch.bfloat16) * 0.8)(B, H, Sk, Dh)),
            "wq": _w((lambda *s: torch.randn(*s, dtype=torch.bfloat16) * 1.6)(D, H * Dh) * (D ** -0.5)),
            "wo": _w((lambda *s: torch.randn(*s, dtype=torch.bfloat16) * 0.8)(H * Dh, D) * ((H * Dh) ** -0.5)),
        }
    _A_in = _A_setup()

    def _B_setup():
        B, S, D, F = 1, 1, 640, 1536
        return {
            "x": _w((lambda *s: torch.randn(*s, dtype=torch.bfloat16) * 0.05)(B, S, D)),
            "W_gate": _w((lambda *s: torch.randn(*s, dtype=torch.bfloat16) * 0.4)(D, F) * (2.0 / D) ** 0.5),
            "W_up": _w((lambda *s: torch.randn(*s, dtype=torch.bfloat16) * 0.4)(D, F) * (2.0 / D) ** 0.5),
            "W_down": _w((lambda *s: torch.randn(*s, dtype=torch.bfloat16) * 0.4)(F, D) * (1.0 / F) ** 0.5),
        }
    _B_in = _B_setup()

    return {
        "A_x": _A_in["x"],
        "A_k_cache": _A_in["k_cache"],
        "A_v_cache": _A_in["v_cache"],
        "A_wq": _A_in["wq"],
        "A_wo": _A_in["wo"],
        "B_x": _B_in["x"],
        "B_W_gate": _B_in["W_gate"],
        "B_W_up": _B_in["W_up"],
        "B_W_down": _B_in["W_down"],
    }

def reference(A_x, A_k_cache, A_v_cache, A_wq, A_wo, B_x, B_W_gate, B_W_up, B_W_down):
    def _A_ref(x, k_cache, v_cache, wq, wo):
        B, Sq, D = x.shape
        H, Dh = 32, 192
        q = (lambda x, *d: x.permute(*d))((x @ wq).reshape(B, Sq, H, Dh), 0, 2, 1, 3)
        scores = torch.einsum("bhqd,bhkd->bhqk", q, k_cache) * (Dh ** -0.5)
        p = _softmax(scores, axis=-1)
        o = torch.einsum("bhqk,bhkd->bhqd", p, v_cache)
        return (lambda x, *d: x.permute(*d))(o, 0, 2, 1, 3).reshape(B, Sq, H * Dh) @ wo

    def _B_ref(x, W_gate, W_up, W_down):
        gate = torch.einsum("bsd,df->bsf", x, W_gate)
        up = torch.einsum("bsd,df->bsf", x, W_up)
        gate = gate * (lambda x, dt: x.to(dt))(gate > 0, gate.dtype)
        h = gate * up
        return torch.einsum("bsf,fd->bsd", h, W_down)

    x = A_x
    h = x + _A_ref(_layernorm(x, axis=-1), A_k_cache, A_v_cache, A_wq, A_wo)
    h2 = h + _B_ref(_layernorm(h, axis=-1), B_W_gate, B_W_up, B_W_down)
    return h2
```

```asm
; @launch grid=(256,1,1) block=(512,1,1) lds=32768
.amdgcn_target "amdgcn-amd-amdhsa--gfx950"
.text
.globl sequential_preLN__mha_block_cached__glu_gated_reglu__decode_kernel
.p2align 8
.type sequential_preLN__mha_block_cached__glu_gated_reglu__decode_kernel,@function
sequential_preLN__mha_block_cached__glu_gated_reglu__decode_kernel:
    s_load_dwordx2 s[40:41], s[0:1], 24
    s_load_dwordx2 s[64:65], s[0:1], 0
    s_cmpk_ge_u32 s2, 256
    s_cbranch_scc1 L_exit
    s_and_b32 s83, s2, 7
    s_lshl3_add_u32 s80, s83, s2
    s_and_b32 s99, s80, 15
    s_mul_i32 s98, s99, 13
    s_lshr_b32 s98, s98, 6
    s_mul_i32 s81, s99, 1572864
    s_mul_i32 s95, s98, 7864064
    s_sub_u32 s81, s81, s95
    s_bfe_u32 s95, s80, 0x40004
    s_mulk_i32 s95, 768
    s_add_u32 s81, s81, s95
    s_add_u32 s95, s81, 786432
    s_cmp_eq_u32 s99, 15
    s_cselect_b32 s42, 0, 7864320
    v_lshrrev_b32 v2, 3, v0
    v_and_b32 v57, 7, v0
    v_mul_u32_u24 v60, 12288, v2
    v_lshl_add_u32 v60, v57, 4, v60
    s_mov_b32 s43, 0x20000
    s_waitcnt lgkmcnt(0)
    buffer_load_dwordx4 v[240:243], v60, s[40:43], s81 offen offset:0 nt
    buffer_load_dwordx4 v[244:247], v60, s[40:43], s81 offen offset:128 nt
    buffer_load_dwordx4 v[248:251], v60, s[40:43], s95 offen offset:0 nt
    buffer_load_dwordx4 v[252:255], v60, s[40:43], s95 offen offset:128 nt
    s_load_dwordx16 s[4:19], s[0:1], 0
    s_load_dwordx8 s[20:27], s[0:1], 64
    v_and_b32 v1, 63, v0
    s_movk_i32 s66, 1280
    s_mov_b32 s67, s43
    v_lshlrev_b32 v60, 4, v1
    buffer_load_dwordx4 v[232:235], v60, s[64:67], 0 offen
    buffer_load_dwordx4 v[236:239], v60, s[64:67], 0 offen offset:1024
    s_cmp_ge_u32 s2, 24
    s_cbranch_scc1 L_nopf
    s_getpc_b64 s[96:97]
    s_andn2_b32 s94, s2, 7
    v_lshl_add_u32 v58, s94, 6, v0
    v_mov_b32 v59, 0
    v_lshl_add_u64 v[58:59], v[58:59], 4, s[96:97]
    global_load_dwordx4 v[208:211], v[58:59], off
L_nopf:
    v_lshrrev_b32 v2, 6, v0
    v_lshrrev_b32 v56, 3, v1
    v_readfirstlane_b32 s3, v2
    v_and_b32 v62, 1, v56
    s_bfe_u32 s82, s80, 0x50003
    s_mul_i32 s81, s98, 5
    s_sub_u32 s99, s99, s81
    s_lshl_b32 s80, s99, 8
    s_lshl4_add_u32 s81, s3, s80
    s_add_u32 s95, s81, 128
    s_lshl3_add_u32 s2, s82, s83
    v_bfe_u32 v2, v1, 2, 2
    v_mul_u32_u24 v2, 768, v2
    v_lshrrev_b32 v3, 5, v1
    v_mul_u32_u24 v3, 384, v3
    v_add_u32 v2, v2, v3
    v_bfe_u32 v3, v1, 4, 1
    v_lshl_add_u32 v2, v3, 6, v2
    v_and_b32 v3, 3, v1
    v_lshl_add_u32 v2, v3, 4, v2
    s_lshl3_add_u32 s48, s83, s3
    s_mul_i32 s48, s48, 3072
    s_mul_i32 s80, s82, 3145728
    s_waitcnt lgkmcnt(0)
    s_load_dwordx4 s[76:79], s[64:65], s81
    s_load_dwordx4 s[72:75], s[64:65], s95
    s_lshr_b32 s15, s82, 0
    s_mul_i32 s15, s15, 19
    s_and_b32 s15, s15, 31
    s_mul_i32 s15, s15, 98304
    s_add_u32 s48, s48, s15
    s_add_u32 s28, s6, s80
    s_addc_u32 s29, s7, 0
    s_mov_b32 s30, 3145728
    s_mov_b32 s31, 0x20000
    s_add_u32 s32, s8, s80
    s_addc_u32 s33, s9, 0
    s_mov_b32 s34, 3145728
    s_mov_b32 s35, 0x20000
    s_waitcnt vmcnt(4)
    s_add_u32 s49, s48, 0
    s_sub_u32 s95, s49, 3145728
    s_min_u32 s49, s49, s95
    buffer_load_dwordx4 v[64:67], v2, s[28:31], s49 offen offset:0 nt
    s_waitcnt vmcnt(4)
    buffer_load_dwordx4 v[68:71], v2, s[28:31], s49 offen offset:128 nt
    s_waitcnt vmcnt(2)
    buffer_load_dwordx4 v[72:75], v2, s[28:31], s49 offen offset:256 nt
    s_waitcnt lgkmcnt(0)
    v_mov_b32 v228, s76
    v_mov_b32 v229, s72
    s_mov_b32 exec_lo, 0xffff0000
    v_mov_b32 v228, s77
    v_mov_b32 v229, s73
    s_mov_b32 exec_lo, 0
    v_mov_b32 v228, s78
    v_mov_b32 v229, s74
    s_mov_b32 exec_hi, 0xffff0000
    v_mov_b32 v228, s79
    v_mov_b32 v229, s75
    s_mov_b64 exec, -1
    v_lshlrev_b32 v62, 4, v62
    v_lshrrev_b32 v228, v62, v228
    v_lshrrev_b32 v229, v62, v229
    s_mov_b32 s36, s26
    s_mov_b32 s37, s27
    s_mov_b32 s38, 402653184
    s_mov_b32 s39, 0x20000
    s_mov_b32 s68, s24
    s_mov_b32 s69, s25
    s_mov_b32 s70, 256
    s_mov_b32 s71, 0x20000
    s_mul_i32 s80, s82, 256
    s_add_u32 s80, s80, 655360
    s_add_u32 s86, s26, s80
    s_addc_u32 s87, s27, 0
    s_lshr_b32 s80, s82, 2
    s_and_b32 s81, s82, 3
    s_mul_i32 s56, s80, 9
    s_lshl_b32 s95, s81, 1
    s_add_u32 s95, s95, 1
    s_mov_b32 s100, 889
    s_cmp_eq_u32 s81, 0
    s_cselect_b32 s95, 0, s95
    s_cselect_b32 s57, 3, 2
    s_cselect_b32 s100, 897, s100
    s_add_u32 s56, s56, s95
    s_mov_b32 s59, s56
    s_mov_b32 s89, 0
    s_mov_b32 s51, 1024
    s_mov_b32 s55, 7
    s_mov_b32 s50, s80
    s_mov_b32 s54, s57
    s_cmp_eq_u32 s83, 7
    s_cbranch_scc0 L_role_a
    s_cmp_eq_u32 s81, 0
    s_cbranch_scc1 L_role_wo
    s_mov_b32 s89, 2
    s_mul_i32 s50, s80, 3
    s_add_u32 s50, s50, s81
    s_sub_u32 s50, s50, 1
    s_mov_b32 s51, 1024
    s_branch L_role_pos
L_role_a:
    s_add_u32 s95, s83, 77
    s_sub_u32 s95, s95, s56
    s_mul_i32 s54, s95, 147
    s_lshr_b32 s54, s54, 10
    s_mul_i32 s54, s54, 7
    s_sub_u32 s54, s95, s54
    s_cmp_lt_u32 s54, s57
    s_cbranch_scc1 L_role_b
    s_add_u32 s54, s54, 1
    s_branch L_role_pos
L_role_b:
    s_add_u32 s56, s56, s54
    s_mul_i32 s50, s56, 147
    s_lshr_b32 s50, s50, 10
    s_mov_b32 s55, s83
    s_cmp_lt_u32 s56, 70
    s_cbranch_scc1 L_role_wo
    s_mov_b32 s55, 7
    s_sub_u32 s50, s56, 62
L_role_wo:
    s_mov_b32 s89, 1
    s_mov_b32 s51, 1024
L_role_pos:
    v_bfe_u32 v63, v1, 4, 1
    v_lshl_add_u32 v63, v63, 3, v57
    v_lshlrev_b32 v63, 4, v63
    v_lshrrev_b32 v58, 5, v1
    v_mul_u32_u24 v58, 768, v58
    s_mul_i32 s80, s3, 1568
    v_add3_u32 v63, v63, v58, s80
    v_mul_u32_u24 v3, 384, v56
    v_lshl_add_u32 v3, v57, 4, v3
    v_and_b32 v58, 1, v1
    v_mov_b32 v59, 0xffff
    v_lshlrev_b32 v58, 4, v58
    v_lshlrev_b32 v59, v58, v59
    s_mov_b32 s90, 0x00ff00ff
    s_mov_b32 s91, 0xff00ff00
    s_mov_b32 s84, 0x3d93cd3a
    s_mov_b32 s85, 0x3fb8aa3b
    v_mov_b32 v4, 0
    v_mov_b32 v5, 0
    v_mov_b32 v6, 0
    v_mov_b32 v7, 0
    s_mov_b32 exec_lo, 50529027
    s_mov_b32 exec_hi, 50529027
    v_mov_b32 v4, v59
    s_mov_b32 exec_lo, 202116108
    s_mov_b32 exec_hi, 202116108
    v_mov_b32 v5, v59
    s_mov_b32 exec_lo, 808464432
    s_mov_b32 exec_hi, 808464432
    v_mov_b32 v6, v59
    s_mov_b32 exec_lo, 3233857728
    s_mov_b32 exec_hi, 3233857728
    v_mov_b32 v7, v59
    s_mov_b64 exec, -1
    v_lshlrev_b32 v212, 16, v232
    v_and_b32 v213, 0xffff0000, v232
    v_lshlrev_b32 v214, 16, v233
    v_and_b32 v215, 0xffff0000, v233
    v_lshlrev_b32 v216, 16, v234
    v_and_b32 v217, 0xffff0000, v234
    v_lshlrev_b32 v218, 16, v235
    v_and_b32 v219, 0xffff0000, v235
    v_lshlrev_b32 v220, 16, v236
    v_and_b32 v221, 0xffff0000, v236
    v_lshlrev_b32 v222, 16, v237
    v_and_b32 v223, 0xffff0000, v237
    v_lshlrev_b32 v224, 16, v238
    v_and_b32 v225, 0xffff0000, v238
    v_lshlrev_b32 v226, 16, v239
    v_and_b32 v227, 0xffff0000, v239
    v_add_f32 v61, v212, v213
    v_mul_f32 v62, v212, v212
    v_fmac_f32 v62, v213, v213
    v_add_f32 v61, v61, v214
    v_fmac_f32 v62, v214, v214
    v_add_f32 v61, v61, v215
    v_fmac_f32 v62, v215, v215
    v_add_f32 v61, v61, v216
    v_fmac_f32 v62, v216, v216
    v_add_f32 v61, v61, v217
    v_fmac_f32 v62, v217, v217
    v_add_f32 v61, v61, v218
    v_fmac_f32 v62, v218, v218
    v_add_f32 v61, v61, v219
    v_fmac_f32 v62, v219, v219
    v_add_f32 v61, v61, v220
    v_fmac_f32 v62, v220, v220
    v_add_f32 v61, v61, v221
    v_fmac_f32 v62, v221, v221
    v_add_f32 v61, v61, v222
    v_fmac_f32 v62, v222, v222
    v_add_f32 v61, v61, v223
    v_fmac_f32 v62, v223, v223
    v_add_f32 v61, v61, v224
    v_fmac_f32 v62, v224, v224
    v_add_f32 v61, v61, v225
    v_fmac_f32 v62, v225, v225
    v_add_f32 v61, v61, v226
    v_fmac_f32 v62, v226, v226
    v_add_f32 v61, v61, v227
    v_fmac_f32 v62, v227, v227
    s_nop 0
    v_add_f32_dpp v61, v61, v61 quad_perm:[1,0,3,2] row_mask:0xf bank_mask:0xf
    v_add_f32_dpp v62, v62, v62 quad_perm:[1,0,3,2] row_mask:0xf bank_mask:0xf
    s_nop 0
    v_add_f32_dpp v61, v61, v61 quad_perm:[2,3,0,1] row_mask:0xf bank_mask:0xf
    v_add_f32_dpp v62, v62, v62 quad_perm:[2,3,0,1] row_mask:0xf bank_mask:0xf
    s_nop 0
    v_add_f32_dpp v61, v61, v61 row_half_mirror row_mask:0xf bank_mask:0xf
    v_add_f32_dpp v62, v62, v62 row_half_mirror row_mask:0xf bank_mask:0xf
    s_nop 0
    v_add_f32_dpp v61, v61, v61 row_ror:8 row_mask:0xf bank_mask:0xf
    v_add_f32_dpp v62, v62, v62 row_ror:8 row_mask:0xf bank_mask:0xf
    s_nop 0
    v_add_f32_dpp v61, v61, v61 row_bcast:15 row_mask:0xa bank_mask:0xf
    v_add_f32_dpp v62, v62, v62 row_bcast:15 row_mask:0xa bank_mask:0xf
    s_nop 0
    v_add_f32_dpp v61, v61, v61 row_bcast:31 row_mask:0xc bank_mask:0xf
    v_add_f32_dpp v62, v62, v62 row_bcast:31 row_mask:0xc bank_mask:0xf
    v_readlane_b32 s80, v61, 63
    v_readlane_b32 s81, v62, 63
    v_mov_b32 v60, 0x3acccccd
    v_mul_f32 v61, s80, v60
    v_mul_f32 v62, s81, v60
    v_fma_f32 v62, -v61, v61, v62
    v_max_f32 v62, 0, v62
    v_cvt_pk_bf16_f32 v61, v61, v61
    v_and_b32 v61, 0xffff0000, v61
    v_cvt_pk_bf16_f32 v62, v62, v62
    v_and_b32 v62, 0xffff0000, v62
    v_add_f32 v62, 0x3727c5ac, v62
    v_cvt_pk_bf16_f32 v62, v62, v62
    v_and_b32 v62, 0xffff0000, v62
    v_sqrt_f32 v62, v62
    s_nop 0
    v_cvt_pk_bf16_f32 v62, v62, v62
    v_and_b32 v62, 0xffff0000, v62
    v_rcp_f32 v62, v62
    v_lshlrev_b32 v228, 16, v228
    v_sub_f32 v228, v228, v61
    v_cvt_pk_bf16_f32 v228, v228, v228
    v_and_b32 v228, 0xffff0000, v228
    v_mul_f32 v228, v228, v62
    v_cvt_pk_bf16_f32 v228, v228, v228
    v_lshlrev_b32 v229, 16, v229
    v_sub_f32 v229, v229, v61
    v_cvt_pk_bf16_f32 v229, v229, v229
    v_and_b32 v229, 0xffff0000, v229
    v_mul_f32 v229, v229, v62
    v_cvt_pk_bf16_f32 v229, v229, v229
    s_waitcnt vmcnt(2)
    s_add_u32 s49, s48, 196608
    s_sub_u32 s95, s49, 3145728
    s_min_u32 s49, s49, s95
    buffer_load_dwordx4 v[76:79], v2, s[28:31], s49 offen offset:0 nt
    s_waitcnt vmcnt(2)
    buffer_load_dwordx4 v[80:83], v2, s[28:31], s49 offen offset:128 nt
    s_waitcnt vmcnt(2)
    buffer_load_dwordx4 v[84:87], v2, s[28:31], s49 offen offset:256 nt
    v_and_b32 v48, v228, v4
    v_and_b32 v49, v228, v5
    v_and_b32 v50, v228, v6
    v_and_b32 v51, v228, v7
    v_and_b32 v52, v229, v4
    v_and_b32 v53, v229, v5
    v_and_b32 v54, v229, v6
    v_and_b32 v55, v229, v7
    v_mfma_f32_16x16x32_bf16 v[36:39], v[240:243], v[48:51], 0
    v_mfma_f32_16x16x32_bf16 v[40:43], v[244:247], v[48:51], 0
    v_mfma_f32_16x16x32_bf16 v[36:39], v[248:251], v[52:55], v[36:39]
    v_mfma_f32_16x16x32_bf16 v[40:43], v[252:255], v[52:55], v[40:43]
    s_mov_b64 exec, s[90:91]
    s_nop 5
    ds_write_b128 v63, v[36:39] offset:3200
    ds_write_b128 v63, v[40:43] offset:3456
    s_mov_b64 exec, -1
    s_waitcnt lgkmcnt(0)
    s_barrier
    s_cmp_lg_u32 s3, 0
    s_cbranch_scc1 L_nw1
    v_lshlrev_b32 v60, 4, v1
    s_mov_b32 exec_hi, 0
    ds_read_b128 v[160:163], v60 offset:3200
    ds_read_b128 v[164:167], v60 offset:3968
    ds_read_b128 v[168:171], v60 offset:4768
    ds_read_b128 v[172:175], v60 offset:5536
    ds_read_b128 v[176:179], v60 offset:6336
    ds_read_b128 v[180:183], v60 offset:7104
    ds_read_b128 v[184:187], v60 offset:7904
    ds_read_b128 v[188:191], v60 offset:8672
    ds_read_b128 v[192:195], v60 offset:9472
    ds_read_b128 v[196:199], v60 offset:10240
    ds_read_b128 v[200:203], v60 offset:11040
    ds_read_b128 v[204:207], v60 offset:11808
    ds_read_b128 v[208:211], v60 offset:12608
    ds_read_b128 v[212:215], v60 offset:13376
    ds_read_b128 v[216:219], v60 offset:14176
    ds_read_b128 v[220:223], v60 offset:14944
    s_mov_b64 exec, -1
    v_mov_b32 v52, -1
    v_mov_b32 v53, -1
    v_mov_b32 v54, -1
    v_mov_b32 v55, -1
    v_lshlrev_b32 v61, 4, v1
    s_lshl_b32 s80, s82, 13
    s_lshl_b32 s95, s83, 10
    s_add_u32 s80, s80, s95
    s_add_u32 s80, s80, 262144
    buffer_store_dwordx4 v[52:55], v61, s[36:39], s80 offen sc1
    s_mul_i32 s80, s82, 256
    s_add_u32 s80, s80, 655360
    s_cmp_eq_u32 s83, 0
    s_cselect_b32 s80, s80, 402653184
    s_mov_b64 exec, 0xff
    buffer_store_dwordx4 v[52:55], v61, s[36:39], s80 offen sc1
    s_lshl_b32 s80, s2, 7
    s_add_u32 s80, s80, 983040
    buffer_store_dwordx4 v[52:55], v61, s[36:39], s80 offen sc1
    s_mov_b64 exec, -1
    s_nop 0
    v_mov_b32 v52, -1
    v_mov_b32 v53, -1
    v_mov_b32 v54, -1
    v_mov_b32 v55, -1
    v_lshlrev_b32 v60, 4, v1
    s_getreg_b32 s80, hwreg(HW_REG_XCC_ID)
    s_add_u32 s80, s80, 1
    v_mov_b32 v61, s80
    s_lshl_b32 s80, s82, 3
    s_cmp_eq_u32 s89, 2
    s_cselect_b32 s80, s80, 256
    s_mov_b64 exec, 1
    buffer_store_dword v61, v60, s[68:71], s80 offen offset:4 sc1
    s_mov_b64 exec, -1
    s_lshr_b32 s80, s55, 1
    s_mul_i32 s80, s80, 11264
    s_mul_i32 s81, s55, 2560
    s_add_u32 s80, s80, s81
    s_lshl_b32 s81, s50, 8
    s_add_u32 s80, s80, s81
    s_add_u32 s80, s80, 1581056
    s_mul_i32 s81, s50, 2560
    s_add_u32 s81, s81, 589824
    s_mul_i32 s74, s89, 256
    s_cmp_eq_u32 s89, 2
    s_cselect_b32 s80, s81, s80
    s_cselect_b32 s74, 2560, s74
    s_add_u32 s72, s26, s80
    s_addc_u32 s73, s27, 0
    s_mov_b32 s75, 0x20000
    buffer_store_dwordx4 v[52:55], v60, s[72:75], 0 offen sc1
    buffer_store_dwordx4 v[52:55], v60, s[72:75], 0 offen offset:1024 sc1
    buffer_store_dwordx4 v[52:55], v60, s[72:75], 0 offen offset:2048 sc1
    s_mov_b32 exec_hi, 0
    s_lshr_b32 s80, s82, 1
    s_mul_i32 s80, s80, 5
    s_add_u32 s80, s80, s99
    s_mul_i32 s80, s80, 3
    s_add_u32 s80, s80, s98
    s_lshl_b32 s80, s80, 9
    s_cmp_eq_u32 s98, 3
    s_cselect_b32 s80, 402653184, s80
    s_waitcnt lgkmcnt(0)
    v_pk_add_f32 v[160:161], v[160:161], v[164:165]
    v_pk_add_f32 v[162:163], v[162:163], v[166:167]
    v_pk_add_f32 v[168:169], v[168:169], v[172:173]
    v_pk_add_f32 v[170:171], v[170:171], v[174:175]
    v_pk_add_f32 v[176:177], v[176:177], v[180:181]
    v_pk_add_f32 v[178:179], v[178:179], v[182:183]
    v_pk_add_f32 v[184:185], v[184:185], v[188:189]
    v_pk_add_f32 v[186:187], v[186:187], v[190:191]
    v_pk_add_f32 v[192:193], v[192:193], v[196:197]
    v_pk_add_f32 v[194:195], v[194:195], v[198:199]
    v_pk_add_f32 v[200:201], v[200:201], v[204:205]
    v_pk_add_f32 v[202:203], v[202:203], v[206:207]
    v_pk_add_f32 v[208:209], v[208:209], v[212:213]
    v_pk_add_f32 v[210:211], v[210:211], v[214:215]
    v_pk_add_f32 v[216:217], v[216:217], v[220:221]
    v_pk_add_f32 v[218:219], v[218:219], v[222:223]
    v_pk_add_f32 v[160:161], v[160:161], v[168:169]
    v_pk_add_f32 v[162:163], v[162:163], v[170:171]
    v_pk_add_f32 v[176:177], v[176:177], v[184:185]
    v_pk_add_f32 v[178:179], v[178:179], v[186:187]
    v_pk_add_f32 v[192:193], v[192:193], v[200:201]
    v_pk_add_f32 v[194:195], v[194:195], v[202:203]
    v_pk_add_f32 v[208:209], v[208:209], v[216:217]
    v_pk_add_f32 v[210:211], v[210:211], v[218:219]
    v_pk_add_f32 v[160:161], v[160:161], v[176:177]
    v_pk_add_f32 v[162:163], v[162:163], v[178:179]
    v_pk_add_f32 v[192:193], v[192:193], v[208:209]
    v_pk_add_f32 v[194:195], v[194:195], v[210:211]
    v_pk_add_f32 v[160:161], v[160:161], v[192:193]
    v_pk_add_f32 v[162:163], v[162:163], v[194:195]
    buffer_store_dwordx4 v[160:163], v60, s[36:39], s80 offen sc1
    s_mov_b64 exec, -1
L_nw1:
    s_cmp_eq_u32 s3, 0
    s_cbranch_scc1 L_rx2
    s_waitcnt vmcnt(2)
L_rx2:
    s_waitcnt vmcnt(10)
    s_add_u32 s49, s48, 393216
    s_sub_u32 s95, s49, 3145728
    s_min_u32 s49, s49, s95
    buffer_load_dwordx4 v[88:91], v2, s[28:31], s49 offen offset:0 nt
    s_cmp_eq_u32 s3, 0
    s_cbranch_scc1 L_rx3
    s_waitcnt vmcnt(2)
L_rx3:
    s_waitcnt vmcnt(10)
    buffer_load_dwordx4 v[92:95], v2, s[28:31], s49 offen offset:128 nt
    s_cmp_eq_u32 s3, 0
    s_cbranch_scc1 L_rx4
    s_waitcnt vmcnt(2)
L_rx4:
    s_waitcnt vmcnt(10)
    buffer_load_dwordx4 v[96:99], v2, s[28:31], s49 offen offset:256 nt
    s_waitcnt vmcnt(2)
    s_add_u32 s49, s48, 589824
    s_sub_u32 s95, s49, 3145728
    s_min_u32 s49, s49, s95
    buffer_load_dwordx4 v[100:103], v2, s[28:31], s49 offen offset:0 nt
    s_cmp_lg_u32 s3, 0
    s_cbranch_scc1 L_nw5
    s_andn2_b32 s80, s82, 1
    s_lshl_b32 s80, s80, 3
    s_add_u32 s96, s24, s80
    s_addc_u32 s97, s25, 0
    s_mov_b32 s88, 1
    s_atomic_add s88, s[96:97], 0 glc
L_nw5:
    s_waitcnt vmcnt(2)
    buffer_load_dwordx4 v[104:107], v2, s[28:31], s49 offen offset:128 nt
    s_waitcnt vmcnt(2)
    buffer_load_dwordx4 v[108:111], v2, s[28:31], s49 offen offset:256 nt
    s_cmp_lg_u32 s3, 0
    s_cbranch_scc1 L_nw6
    s_andn2_b32 s80, s82, 1
    s_lshl_b32 s80, s80, 10
    s_add_u32 s80, s80, 983040
    s_add_u32 s98, s26, s80
    s_addc_u32 s99, s27, 0
    s_waitcnt lgkmcnt(0)
    s_and_b32 s88, s88, 15
    s_cmp_eq_u32 s88, 15
    s_cbranch_scc0 L_nogo
    s_mov_b32 s95, 1
    s_atomic_add s95, s[98:99], 0
    s_atomic_add s95, s[98:99], 128
    s_atomic_add s95, s[98:99], 256
    s_atomic_add s95, s[98:99], 384
    s_atomic_add s95, s[98:99], 512
    s_atomic_add s95, s[98:99], 640
    s_atomic_add s95, s[98:99], 768
    s_atomic_add s95, s[98:99], 896
    s_atomic_add s95, s[98:99], 1024
    s_atomic_add s95, s[98:99], 1152
    s_waitcnt lgkmcnt(4)
    s_atomic_add s95, s[98:99], 1280
    s_atomic_add s95, s[98:99], 1408
    s_atomic_add s95, s[98:99], 1536
    s_atomic_add s95, s[98:99], 1664
    s_atomic_add s95, s[98:99], 1792
    s_atomic_add s95, s[98:99], 1920
    s_atomic_add s95, s[24:25], 4
    s_waitcnt lgkmcnt(0)
L_nogo:
L_nw6:
    s_cmp_lg_u32 s3, 0
    s_cbranch_scc1 L_nw7
    s_lshl_b32 s80, s2, 7
    s_add_u32 s80, s80, 983040
    s_add_u32 s98, s26, s80
    s_addc_u32 s99, s27, 0
    s_load_dword s88, s[98:99], 0 glc
L_nw7:
    s_waitcnt vmcnt(2)
    s_add_u32 s49, s48, 786432
    s_sub_u32 s95, s49, 3145728
    s_min_u32 s49, s49, s95
    buffer_load_dwordx4 v[112:115], v2, s[28:31], s49 offen offset:0 nt
    s_waitcnt vmcnt(2)
    buffer_load_dwordx4 v[116:119], v2, s[28:31], s49 offen offset:128 nt
    s_waitcnt vmcnt(2)
    buffer_load_dwordx4 v[120:123], v2, s[28:31], s49 offen offset:256 nt
    s_cmp_lg_u32 s3, 0
    s_cbranch_scc1 L_nw8
    s_waitcnt lgkmcnt(0)
    s_cmp_lg_u32 s88, -1
    s_cbranch_scc1 L_gook
    s_lshl_b32 s80, s2, 7
    s_add_u32 s80, s80, 983040
    s_add_u32 s98, s26, s80
    s_addc_u32 s99, s27, 0
    s_mov_b32 s94, 1048576
L_poll9:
    s_load_dword s88, s[98:99], 0 glc
    s_waitcnt lgkmcnt(0)
    s_cmp_lg_u32 s88, -1
    s_cbranch_scc1 L_pok9
    s_sleep 1
    s_sub_u32 s94, s94, 1
    s_cmp_lg_u32 s94, 0
    s_cbranch_scc1 L_poll9
L_pok9:
L_gook:
    s_lshr_b32 s80, s82, 1
    s_mul_i32 s80, s80, 7680
    s_and_b32 s81, s82, 1
    s_mul_i32 s81, s81, 768
    s_add_u32 s80, s80, s81
    s_add_u32 s81, s80, 4608
    v_lshlrev_b32 v60, 4, v1
    s_mov_b32 exec_hi, 0xffff
    buffer_load_dwordx4 v[220:223], v60, s[36:39], s80 offen offset:0 sc1
    buffer_load_dwordx4 v[224:227], v60, s[36:39], s80 offen offset:1536 sc1
    buffer_load_dwordx4 v[228:231], v60, s[36:39], s80 offen offset:3072 sc1
    buffer_load_dwordx4 v[232:235], v60, s[36:39], s81 offen offset:0 sc1
    buffer_load_dwordx4 v[236:239], v60, s[36:39], s81 offen offset:1536 sc1
    s_mov_b64 exec, -1
L_nw8:
    s_cmp_eq_u32 s3, 0
    s_cbranch_scc1 L_rx10
    s_waitcnt vmcnt(2)
L_rx10:
    s_waitcnt vmcnt(7)
    s_add_u32 s49, s48, 983040
    s_sub_u32 s95, s49, 3145728
    s_min_u32 s49, s49, s95
    buffer_load_dwordx4 v[124:127], v2, s[28:31], s49 offen offset:0 nt
    s_cmp_eq_u32 s3, 0
    s_cbranch_scc1 L_rx11
    s_waitcnt vmcnt(2)
L_rx11:
    s_waitcnt vmcnt(7)
    buffer_load_dwordx4 v[128:131], v2, s[28:31], s49 offen offset:128 nt
    s_cmp_eq_u32 s3, 0
    s_cbranch_scc1 L_rx12
    s_waitcnt vmcnt(2)
L_rx12:
    s_waitcnt vmcnt(7)
    buffer_load_dwordx4 v[132:135], v2, s[28:31], s49 offen offset:256 nt
    s_mul_i32 s80, s59, 147
    s_lshr_b32 s80, s80, 10
    s_mul_i32 s80, s80, 7
    s_sub_u32 s72, s59, s80
    s_mov_b32 s73, 0
    s_and_b32 s81, s82, 3
    s_cbranch_scc1 L_hol_c
    s_mov_b32 s60, 234501224
    s_mov_b32 s61, 15713159
    s_mov_b32 s76, 0
    s_mov_b32 s77, 0
    s_lshl_b64 s[62:63], s[72:73], 0
    s_or_b64 s[60:61], s[60:61], s[62:63]
    s_lshl_b64 s[62:63], s[72:73], 28
    s_or_b64 s[60:61], s[60:61], s[62:63]
    s_add_u32 s72, s72, 1
    s_cmp_eq_u32 s72, 7
    s_cselect_b32 s72, 0, s72
    s_lshl_b64 s[62:63], s[72:73], 7
    s_or_b64 s[60:61], s[60:61], s[62:63]
    s_lshl_b64 s[62:63], s[72:73], 35
    s_or_b64 s[60:61], s[60:61], s[62:63]
    s_add_u32 s72, s72, 1
    s_cmp_eq_u32 s72, 7
    s_cselect_b32 s72, 0, s72
    s_lshl_b64 s[62:63], s[72:73], 14
    s_or_b64 s[60:61], s[60:61], s[62:63]
    s_lshl_b64 s[62:63], s[72:73], 42
    s_or_b64 s[60:61], s[60:61], s[62:63]
    s_branch L_hol_e
L_hol_c:
    s_mov_b32 s60, 2367287255
    s_mov_b32 s61, 2011284350
    s_mov_b32 s76, 0
    s_mov_b32 s77, 0
    s_lshl_b64 s[62:63], s[72:73], 21
    s_or_b64 s[60:61], s[60:61], s[62:63]
    s_lshl_b64 s[62:63], s[72:73], 42
    s_or_b64 s[60:61], s[60:61], s[62:63]
    s_add_u32 s72, s72, 1
    s_cmp_eq_u32 s72, 7
    s_cselect_b32 s72, 0, s72
    s_lshl_b64 s[62:63], s[72:73], 28
    s_or_b64 s[60:61], s[60:61], s[62:63]
    s_lshl_b64 s[62:63], s[72:73], 49
    s_or_b64 s[60:61], s[60:61], s[62:63]
L_hol_e:
    s_waitcnt vmcnt(2)
    s_add_u32 s49, s48, 1179648
    s_sub_u32 s95, s49, 3145728
    s_min_u32 s49, s49, s95
    buffer_load_dwordx4 v[136:139], v2, s[28:31], s49 offen offset:0 nt
    s_waitcnt vmcnt(2)
    buffer_load_dwordx4 v[140:143], v2, s[28:31], s49 offen offset:128 nt
    s_waitcnt vmcnt(2)
    buffer_load_dwordx4 v[144:147], v2, s[28:31], s49 offen offset:256 nt
    s_cmp_lg_u32 s3, 0
    s_cbranch_scc1 L_nw13
    v_pk_add_f32 v[220:221], v[220:221], v[224:225]
    v_pk_add_f32 v[222:223], v[222:223], v[226:227]
    v_pk_add_f32 v[220:221], v[220:221], v[228:229]
    v_pk_add_f32 v[222:223], v[222:223], v[230:231]
    v_pk_add_f32 v[220:221], v[220:221], v[232:233]
    v_pk_add_f32 v[222:223], v[222:223], v[234:235]
    v_pk_add_f32 v[220:221], v[220:221], v[236:237]
    v_pk_add_f32 v[222:223], v[222:223], v[238:239]
    v_lshlrev_b32 v61, 6, v56
    v_lshl_add_u32 v61, v57, 1, v61
    v_cvt_pk_bf16_f32 v48, v220, v221
    v_cvt_pk_bf16_f32 v49, v222, v223
    s_mov_b32 exec_hi, 0xffff
    ds_write_b16 v61, v48 offset:64
    ds_write_b16_d16_hi v61, v48 offset:80
    ds_write_b16 v61, v49 offset:96
    ds_write_b16_d16_hi v61, v49 offset:112
    s_mov_b64 exec, -1
    v_mov_b32 v60, 0
    v_mov_b32 v61, 1
    ds_write_b32 v60, v61 offset:0
L_nw13:
    s_waitcnt vmcnt(2)
    s_add_u32 s49, s48, 1376256
    s_sub_u32 s95, s49, 3145728
    s_min_u32 s49, s49, s95
    buffer_load_dwordx4 v[148:151], v2, s[28:31], s49 offen offset:0 nt
    s_waitcnt vmcnt(2)
    buffer_load_dwordx4 v[152:155], v2, s[28:31], s49 offen offset:128 nt
    s_waitcnt vmcnt(2)
    buffer_load_dwordx4 v[156:159], v2, s[28:31], s49 offen offset:256 nt
    s_waitcnt lgkmcnt(0)
    s_barrier
    v_mov_b32 v8, 0
    v_mov_b32 v9, 0
    v_mov_b32 v10, 0
    v_mov_b32 v11, 0
    v_mov_b32 v12, 0
    v_mov_b32 v13, 0
    v_mov_b32 v14, 0
    v_mov_b32 v15, 0
    v_mov_b32 v16, 0
    v_mov_b32 v17, 0
    v_mov_b32 v18, 0
    v_mov_b32 v19, 0
    v_bfe_u32 v60, v1, 4, 1
    v_lshlrev_b32 v60, 6, v60
    v_and_b32 v61, 3, v1
    v_lshl_add_u32 v60, v61, 4, v60
    s_mov_b64 exec, s[90:91]
    ds_read_b128 v[8:11], v60 offset:64
    ds_read_b128 v[12:15], v60 offset:192
    ds_read_b128 v[16:19], v60 offset:320
    s_mov_b64 exec, -1
    s_waitcnt lgkmcnt(0)
    v_mfma_f32_16x16x32_bf16 v[48:51], v[64:67], v[8:11], 0
    v_mfma_f32_16x16x32_bf16 v[48:51], v[68:71], v[12:15], v[48:51]
    v_mfma_f32_16x16x32_bf16 v[48:51], v[72:75], v[16:19], v[48:51]
    v_mfma_f32_16x16x32_bf16 v[52:55], v[76:79], v[8:11], 0
    v_mfma_f32_16x16x32_bf16 v[52:55], v[80:83], v[12:15], v[52:55]
    v_mfma_f32_16x16x32_bf16 v[52:55], v[84:87], v[16:19], v[52:55]
    s_nop 4
    v_mov_b32_dpp v20, v48 quad_perm:[0,0,0,0] row_mask:0xf bank_mask:0xf
    v_add_f32_dpp v20, v49, v20 quad_perm:[1,1,1,1] row_mask:0xf bank_mask:0xf
    v_add_f32_dpp v20, v50, v20 quad_perm:[2,2,2,2] row_mask:0xf bank_mask:0xf
    v_add_f32_dpp v20, v51, v20 quad_perm:[3,3,3,3] row_mask:0xf bank_mask:0xf
    v_cvt_pk_bf16_f32 v20, v20, v20
    v_and_b32 v20, 0xffff0000, v20
    v_mul_f32 v20, s84, v20
    v_cvt_pk_bf16_f32 v20, v20, v20
    v_and_b32 v20, 0xffff0000, v20
    v_mov_b32_dpp v21, v52 quad_perm:[0,0,0,0] row_mask:0xf bank_mask:0xf
    v_add_f32_dpp v21, v53, v21 quad_perm:[1,1,1,1] row_mask:0xf bank_mask:0xf
    v_add_f32_dpp v21, v54, v21 quad_perm:[2,2,2,2] row_mask:0xf bank_mask:0xf
    v_add_f32_dpp v21, v55, v21 quad_perm:[3,3,3,3] row_mask:0xf bank_mask:0xf
    v_cvt_pk_bf16_f32 v21, v21, v21
    v_and_b32 v21, 0xffff0000, v21
    v_mul_f32 v21, s84, v21
    v_cvt_pk_bf16_f32 v21, v21, v21
    v_and_b32 v21, 0xffff0000, v21
    v_mfma_f32_16x16x32_bf16 v[48:51], v[88:91], v[8:11], 0
    v_mfma_f32_16x16x32_bf16 v[48:51], v[92:95], v[12:15], v[48:51]
    v_mfma_f32_16x16x32_bf16 v[48:51], v[96:99], v[16:19], v[48:51]
    v_mfma_f32_16x16x32_bf16 v[52:55], v[100:103], v[8:11], 0
    v_mfma_f32_16x16x32_bf16 v[52:55], v[104:107], v[12:15], v[52:55]
    v_mfma_f32_16x16x32_bf16 v[52:55], v[108:111], v[16:19], v[52:55]
    s_nop 4
    v_mov_b32_dpp v22, v48 quad_perm:[0,0,0,0] row_mask:0xf bank_mask:0xf
    v_add_f32_dpp v22, v49, v22 quad_perm:[1,1,1,1] row_mask:0xf bank_mask:0xf
    v_add_f32_dpp v22, v50, v22 quad_perm:[2,2,2,2] row_mask:0xf bank_mask:0xf
    v_add_f32_dpp v22, v51, v22 quad_perm:[3,3,3,3] row_mask:0xf bank_mask:0xf
    v_cvt_pk_bf16_f32 v22, v22, v22
    v_and_b32 v22, 0xffff0000, v22
    v_mul_f32 v22, s84, v22
    v_cvt_pk_bf16_f32 v22, v22, v22
    v_and_b32 v22, 0xffff0000, v22
    v_mov_b32_dpp v23, v52 quad_perm:[0,0,0,0] row_mask:0xf bank_mask:0xf
    v_add_f32_dpp v23, v53, v23 quad_perm:[1,1,1,1] row_mask:0xf bank_mask:0xf
    v_add_f32_dpp v23, v54, v23 quad_perm:[2,2,2,2] row_mask:0xf bank_mask:0xf
    v_add_f32_dpp v23, v55, v23 quad_perm:[3,3,3,3] row_mask:0xf bank_mask:0xf
    v_cvt_pk_bf16_f32 v23, v23, v23
    v_and_b32 v23, 0xffff0000, v23
    v_mul_f32 v23, s84, v23
    v_cvt_pk_bf16_f32 v23, v23, v23
    v_and_b32 v23, 0xffff0000, v23
    v_mfma_f32_16x16x32_bf16 v[48:51], v[112:115], v[8:11], 0
    v_mfma_f32_16x16x32_bf16 v[48:51], v[116:119], v[12:15], v[48:51]
    v_mfma_f32_16x16x32_bf16 v[48:51], v[120:123], v[16:19], v[48:51]
    v_mfma_f32_16x16x32_bf16 v[52:55], v[124:127], v[8:11], 0
    v_mfma_f32_16x16x32_bf16 v[52:55], v[128:131], v[12:15], v[52:55]
    v_mfma_f32_16x16x32_bf16 v[52:55], v[132:135], v[16:19], v[52:55]
    s_nop 4
    v_mov_b32_dpp v24, v48 quad_perm:[0,0,0,0] row_mask:0xf bank_mask:0xf
    v_add_f32_dpp v24, v49, v24 quad_perm:[1,1,1,1] row_mask:0xf bank_mask:0xf
    v_add_f32_dpp v24, v50, v24 quad_perm:[2,2,2,2] row_mask:0xf bank_mask:0xf
    v_add_f32_dpp v24, v51, v24 quad_perm:[3,3,3,3] row_mask:0xf bank_mask:0xf
    v_cvt_pk_bf16_f32 v24, v24, v24
    v_and_b32 v24, 0xffff0000, v24
    v_mul_f32 v24, s84, v24
    v_cvt_pk_bf16_f32 v24, v24, v24
    v_and_b32 v24, 0xffff0000, v24
    v_mov_b32_dpp v25, v52 quad_perm:[0,0,0,0] row_mask:0xf bank_mask:0xf
    v_add_f32_dpp v25, v53, v25 quad_perm:[1,1,1,1] row_mask:0xf bank_mask:0xf
    v_add_f32_dpp v25, v54, v25 quad_perm:[2,2,2,2] row_mask:0xf bank_mask:0xf
    v_add_f32_dpp v25, v55, v25 quad_perm:[3,3,3,3] row_mask:0xf bank_mask:0xf
    v_cvt_pk_bf16_f32 v25, v25, v25
    v_and_b32 v25, 0xffff0000, v25
    v_mul_f32 v25, s84, v25
    v_cvt_pk_bf16_f32 v25, v25, v25
    v_and_b32 v25, 0xffff0000, v25
    s_waitcnt vmcnt(2)
    s_add_u32 s49, s48, 1572864
    s_sub_u32 s95, s49, 3145728
    s_min_u32 s49, s49, s95
    buffer_load_dwordx4 v[160:163], v2, s[28:31], s49 offen offset:0 nt
    s_waitcnt vmcnt(2)
    buffer_load_dwordx4 v[164:167], v2, s[28:31], s49 offen offset:128 nt
    s_waitcnt vmcnt(2)
    buffer_load_dwordx4 v[168:171], v2, s[28:31], s49 offen offset:256 nt
    v_mfma_f32_16x16x32_bf16 v[48:51], v[136:139], v[8:11], 0
    v_mfma_f32_16x16x32_bf16 v[48:51], v[140:143], v[12:15], v[48:51]
    v_mfma_f32_16x16x32_bf16 v[48:51], v[144:147], v[16:19], v[48:51]
    v_mfma_f32_16x16x32_bf16 v[52:55], v[148:151], v[8:11], 0
    v_mfma_f32_16x16x32_bf16 v[52:55], v[152:155], v[12:15], v[52:55]
    v_mfma_f32_16x16x32_bf16 v[52:55], v[156:159], v[16:19], v[52:55]
    s_nop 4
    v_mov_b32_dpp v26, v48 quad_perm:[0,0,0,0] row_mask:0xf bank_mask:0xf
    v_add_f32_dpp v26, v49, v26 quad_perm:[1,1,1,1] row_mask:0xf bank_mask:0xf
    v_add_f32_dpp v26, v50, v26 quad_perm:[2,2,2,2] row_mask:0xf bank_mask:0xf
    v_add_f32_dpp v26, v51, v26 quad_perm:[3,3,3,3] row_mask:0xf bank_mask:0xf
    v_cvt_pk_bf16_f32 v26, v26, v26
    v_and_b32 v26, 0xffff0000, v26
    v_mul_f32 v26, s84, v26
    v_cvt_pk_bf16_f32 v26, v26, v26
    v_and_b32 v26, 0xffff0000, v26
    v_mov_b32_dpp v27, v52 quad_perm:[0,0,0,0] row_mask:0xf bank_mask:0xf
    v_add_f32_dpp v27, v53, v27 quad_perm:[1,1,1,1] row_mask:0xf bank_mask:0xf
    v_add_f32_dpp v27, v54, v27 quad_perm:[2,2,2,2] row_mask:0xf bank_mask:0xf
    v_add_f32_dpp v27, v55, v27 quad_perm:[3,3,3,3] row_mask:0xf bank_mask:0xf
    v_cvt_pk_bf16_f32 v27, v27, v27
    v_and_b32 v27, 0xffff0000, v27
    v_mul_f32 v27, s84, v27
    v_cvt_pk_bf16_f32 v27, v27, v27
    v_and_b32 v27, 0xffff0000, v27
    s_waitcnt vmcnt(2)
    s_add_u32 s49, s48, 1769472
    s_sub_u32 s95, s49, 3145728
    s_min_u32 s49, s49, s95
    buffer_load_dwordx4 v[172:175], v2, s[28:31], s49 offen offset:0 nt
    s_waitcnt vmcnt(2)
    buffer_load_dwordx4 v[176:179], v2, s[28:31], s49 offen offset:128 nt
    s_waitcnt vmcnt(2)
    buffer_load_dwordx4 v[180:183], v2, s[28:31], s49 offen offset:256 nt
    v_mfma_f32_16x16x32_bf16 v[48:51], v[160:163], v[8:11], 0
    v_mfma_f32_16x16x32_bf16 v[48:51], v[164:167], v[12:15], v[48:51]
    v_mfma_f32_16x16x32_bf16 v[48:51], v[168:171], v[16:19], v[48:51]
    s_nop 7
    v_mov_b32_dpp v28, v48 quad_perm:[0,0,0,0] row_mask:0xf bank_mask:0xf
    v_add_f32_dpp v28, v49, v28 quad_perm:[1,1,1,1] row_mask:0xf bank_mask:0xf
    v_add_f32_dpp v28, v50, v28 quad_perm:[2,2,2,2] row_mask:0xf bank_mask:0xf
    v_add_f32_dpp v28, v51, v28 quad_perm:[3,3,3,3] row_mask:0xf bank_mask:0xf
    v_cvt_pk_bf16_f32 v28, v28, v28
    v_and_b32 v28, 0xffff0000, v28
    v_mul_f32 v28, s84, v28
    v_cvt_pk_bf16_f32 v28, v28, v28
    v_and_b32 v28, 0xffff0000, v28
    s_waitcnt vmcnt(2)
    s_cmp_eq_u32 s89, 1
    s_cbranch_scc1 L_st_wo
    s_cmp_eq_u32 s89, 2
    s_cbranch_scc1 L_st_ffn
    s_add_u32 s49, s48, 1966080
    s_sub_u32 s95, s49, 3145728
    s_min_u32 s49, s49, s95
    buffer_load_dwordx4 v[184:187], v2, s[28:31], s49 offen offset:0 nt
    s_waitcnt vmcnt(3)
    buffer_load_dwordx4 v[188:191], v2, s[28:31], s49 offen offset:128 nt
    s_waitcnt vmcnt(3)
    buffer_load_dwordx4 v[192:195], v2, s[28:31], s49 offen offset:256 nt
    s_waitcnt vmcnt(1)
    s_add_u32 s49, s48, 2162688
    s_sub_u32 s95, s49, 3145728
    s_min_u32 s49, s49, s95
    buffer_load_dwordx4 v[196:199], v2, s[28:31], s49 offen offset:0 nt
    s_waitcnt vmcnt(3)
    buffer_load_dwordx4 v[200:203], v2, s[28:31], s49 offen offset:128 nt
    s_waitcnt vmcnt(3)
    buffer_load_dwordx4 v[204:207], v2, s[28:31], s49 offen offset:256 nt
    v_mfma_f32_16x16x32_bf16 v[48:51], v[172:175], v[8:11], 0
    v_mfma_f32_16x16x32_bf16 v[48:51], v[176:179], v[12:15], v[48:51]
    v_mfma_f32_16x16x32_bf16 v[48:51], v[180:183], v[16:19], v[48:51]
    s_nop 7
    v_mov_b32_dpp v29, v48 quad_perm:[0,0,0,0] row_mask:0xf bank_mask:0xf
    v_add_f32_dpp v29, v49, v29 quad_perm:[1,1,1,1] row_mask:0xf bank_mask:0xf
    v_add_f32_dpp v29, v50, v29 quad_perm:[2,2,2,2] row_mask:0xf bank_mask:0xf
    v_add_f32_dpp v29, v51, v29 quad_perm:[3,3,3,3] row_mask:0xf bank_mask:0xf
    v_cvt_pk_bf16_f32 v29, v29, v29
    v_and_b32 v29, 0xffff0000, v29
    v_mul_f32 v29, s84, v29
    v_cvt_pk_bf16_f32 v29, v29, v29
    v_and_b32 v29, 0xffff0000, v29
    s_waitcnt vmcnt(1)
    s_add_u32 s49, s48, 2359296
    s_sub_u32 s95, s49, 3145728
    s_min_u32 s49, s49, s95
    buffer_load_dwordx4 v[208:211], v2, s[28:31], s49 offen offset:0 nt
    s_waitcnt vmcnt(3)
    buffer_load_dwordx4 v[212:215], v2, s[28:31], s49 offen offset:128 nt
    s_waitcnt vmcnt(3)
    buffer_load_dwordx4 v[216:219], v2, s[28:31], s49 offen offset:256 nt
    v_mfma_f32_16x16x32_bf16 v[48:51], v[184:187], v[8:11], 0
    v_mfma_f32_16x16x32_bf16 v[48:51], v[188:191], v[12:15], v[48:51]
    v_mfma_f32_16x16x32_bf16 v[48:51], v[192:195], v[16:19], v[48:51]
    s_nop 7
    v_mov_b32_dpp v30, v48 quad_perm:[0,0,0,0] row_mask:0xf bank_mask:0xf
    v_add_f32_dpp v30, v49, v30 quad_perm:[1,1,1,1] row_mask:0xf bank_mask:0xf
    v_add_f32_dpp v30, v50, v30 quad_perm:[2,2,2,2] row_mask:0xf bank_mask:0xf
    v_add_f32_dpp v30, v51, v30 quad_perm:[3,3,3,3] row_mask:0xf bank_mask:0xf
    v_cvt_pk_bf16_f32 v30, v30, v30
    v_and_b32 v30, 0xffff0000, v30
    v_mul_f32 v30, s84, v30
    v_cvt_pk_bf16_f32 v30, v30, v30
    v_and_b32 v30, 0xffff0000, v30
    s_waitcnt vmcnt(1)
    s_add_u32 s49, s48, 2555904
    s_sub_u32 s95, s49, 3145728
    s_min_u32 s49, s49, s95
    buffer_load_dwordx4 v[220:223], v2, s[28:31], s49 offen offset:0 nt
    s_waitcnt vmcnt(3)
    buffer_load_dwordx4 v[224:227], v2, s[28:31], s49 offen offset:128 nt
    s_waitcnt vmcnt(3)
    buffer_load_dwordx4 v[228:231], v2, s[28:31], s49 offen offset:256 nt
    v_mfma_f32_16x16x32_bf16 v[48:51], v[196:199], v[8:11], 0
    v_mfma_f32_16x16x32_bf16 v[48:51], v[200:203], v[12:15], v[48:51]
    v_mfma_f32_16x16x32_bf16 v[48:51], v[204:207], v[16:19], v[48:51]
    s_nop 7
    v_mov_b32_dpp v31, v48 quad_perm:[0,0,0,0] row_mask:0xf bank_mask:0xf
    v_add_f32_dpp v31, v49, v31 quad_perm:[1,1,1,1] row_mask:0xf bank_mask:0xf
    v_add_f32_dpp v31, v50, v31 quad_perm:[2,2,2,2] row_mask:0xf bank_mask:0xf
    v_add_f32_dpp v31, v51, v31 quad_perm:[3,3,3,3] row_mask:0xf bank_mask:0xf
    v_cvt_pk_bf16_f32 v31, v31, v31
    v_and_b32 v31, 0xffff0000, v31
    v_mul_f32 v31, s84, v31
    v_cvt_pk_bf16_f32 v31, v31, v31
    v_and_b32 v31, 0xffff0000, v31
    s_waitcnt vmcnt(1)
    s_add_u32 s49, s48, 2752512
    s_sub_u32 s95, s49, 3145728
    s_min_u32 s49, s49, s95
    buffer_load_dwordx4 v[232:235], v2, s[28:31], s49 offen offset:0 nt
    s_waitcnt vmcnt(3)
    buffer_load_dwordx4 v[236:239], v2, s[28:31], s49 offen offset:128 nt
    s_waitcnt vmcnt(3)
    buffer_load_dwordx4 v[240:243], v2, s[28:31], s49 offen offset:256 nt
    v_mfma_f32_16x16x32_bf16 v[48:51], v[208:211], v[8:11], 0
    v_mfma_f32_16x16x32_bf16 v[48:51], v[212:215], v[12:15], v[48:51]
    v_mfma_f32_16x16x32_bf16 v[48:51], v[216:219], v[16:19], v[48:51]
    s_nop 7
    v_mov_b32_dpp v32, v48 quad_perm:[0,0,0,0] row_mask:0xf bank_mask:0xf
    v_add_f32_dpp v32, v49, v32 quad_perm:[1,1,1,1] row_mask:0xf bank_mask:0xf
    v_add_f32_dpp v32, v50, v32 quad_perm:[2,2,2,2] row_mask:0xf bank_mask:0xf
    v_add_f32_dpp v32, v51, v32 quad_perm:[3,3,3,3] row_mask:0xf bank_mask:0xf
    v_cvt_pk_bf16_f32 v32, v32, v32
    v_and_b32 v32, 0xffff0000, v32
    v_mul_f32 v32, s84, v32
    v_cvt_pk_bf16_f32 v32, v32, v32
    v_and_b32 v32, 0xffff0000, v32
    s_waitcnt vmcnt(1)
    s_add_u32 s49, s48, 0
    s_sub_u32 s95, s49, 3145728
    s_min_u32 s49, s49, s95
    buffer_load_dwordx4 v[88:91], v3, s[32:35], s49 offen offset:0 nt
    s_waitcnt vmcnt(3)
    buffer_load_dwordx4 v[92:95], v3, s[32:35], s49 offen offset:128 nt
    s_waitcnt vmcnt(3)
    buffer_load_dwordx4 v[96:99], v3, s[32:35], s49 offen offset:256 nt
    v_mfma_f32_16x16x32_bf16 v[48:51], v[220:223], v[8:11], 0
    v_mfma_f32_16x16x32_bf16 v[48:51], v[224:227], v[12:15], v[48:51]
    v_mfma_f32_16x16x32_bf16 v[48:51], v[228:231], v[16:19], v[48:51]
    s_nop 7
    v_mov_b32_dpp v33, v48 quad_perm:[0,0,0,0] row_mask:0xf bank_mask:0xf
    v_add_f32_dpp v33, v49, v33 quad_perm:[1,1,1,1] row_mask:0xf bank_mask:0xf
    v_add_f32_dpp v33, v50, v33 quad_perm:[2,2,2,2] row_mask:0xf bank_mask:0xf
    v_add_f32_dpp v33, v51, v33 quad_perm:[3,3,3,3] row_mask:0xf bank_mask:0xf
    v_cvt_pk_bf16_f32 v33, v33, v33
    v_and_b32 v33, 0xffff0000, v33
    v_mul_f32 v33, s84, v33
    v_cvt_pk_bf16_f32 v33, v33, v33
    v_and_b32 v33, 0xffff0000, v33
    s_waitcnt vmcnt(1)
    s_add_u32 s49, s48, 196608
    s_sub_u32 s95, s49, 3145728
    s_min_u32 s49, s49, s95
    buffer_load_dwordx4 v[100:103], v3, s[32:35], s49 offen offset:0 nt
    s_waitcnt vmcnt(3)
    buffer_load_dwordx4 v[104:107], v3, s[32:35], s49 offen offset:128 nt
    s_waitcnt vmcnt(3)
    buffer_load_dwordx4 v[108:111], v3, s[32:35], s49 offen offset:256 nt
    v_mfma_f32_16x16x32_bf16 v[48:51], v[232:235], v[8:11], 0
    v_mfma_f32_16x16x32_bf16 v[48:51], v[236:239], v[12:15], v[48:51]
    v_mfma_f32_16x16x32_bf16 v[48:51], v[240:243], v[16:19], v[48:51]
    s_nop 7
    v_mov_b32_dpp v34, v48 quad_perm:[0,0,0,0] row_mask:0xf bank_mask:0xf
    v_add_f32_dpp v34, v49, v34 quad_perm:[1,1,1,1] row_mask:0xf bank_mask:0xf
    v_add_f32_dpp v34, v50, v34 quad_perm:[2,2,2,2] row_mask:0xf bank_mask:0xf
    v_add_f32_dpp v34, v51, v34 quad_perm:[3,3,3,3] row_mask:0xf bank_mask:0xf
    v_cvt_pk_bf16_f32 v34, v34, v34
    v_and_b32 v34, 0xffff0000, v34
    v_mul_f32 v34, s84, v34
    v_cvt_pk_bf16_f32 v34, v34, v34
    v_and_b32 v34, 0xffff0000, v34
    v_max_f32 v58, v20, v21
    v_max3_f32 v58, v58, v22, v23
    v_max3_f32 v58, v58, v24, v25
    v_max3_f32 v58, v58, v26, v27
    v_max3_f32 v58, v58, v28, v29
    v_max3_f32 v58, v58, v30, v31
    v_max3_f32 v58, v58, v32, v33
    v_max_f32 v58, v58, v34
    s_nop 1
    v_max_f32_dpp v58, v58, v58 row_ror:8 row_mask:0xf bank_mask:0xf
    s_nop 1
    v_max_f32_dpp v58, v58, v58 row_bcast:15 row_mask:0xa bank_mask:0xf
    s_nop 1
    v_max_f32_dpp v58, v58, v58 row_bcast:31 row_mask:0xc bank_mask:0xf
    s_nop 0
    v_readlane_b32 s80, v58, 63
    s_nop 1
    v_mov_b32 v58, s80
    v_sub_f32 v20, v20, v58
    v_sub_f32 v21, v21, v58
    v_sub_f32 v22, v22, v58
    v_sub_f32 v23, v23, v58
    v_sub_f32 v24, v24, v58
    v_sub_f32 v25, v25, v58
    v_sub_f32 v26, v26, v58
    v_sub_f32 v27, v27, v58
    v_sub_f32 v28, v28, v58
    v_sub_f32 v29, v29, v58
    v_sub_f32 v30, v30, v58
    v_sub_f32 v31, v31, v58
    v_sub_f32 v32, v32, v58
    v_sub_f32 v33, v33, v58
    v_sub_f32 v34, v34, v58
    v_mul_f32 v20, s85, v20
    v_mul_f32 v21, s85, v21
    v_mul_f32 v22, s85, v22
    v_mul_f32 v23, s85, v23
    v_mul_f32 v24, s85, v24
    v_mul_f32 v25, s85, v25
    v_mul_f32 v26, s85, v26
    v_mul_f32 v27, s85, v27
    v_mul_f32 v28, s85, v28
    v_mul_f32 v29, s85, v29
    v_mul_f32 v30, s85, v30
    v_mul_f32 v31, s85, v31
    v_mul_f32 v32, s85, v32
    v_mul_f32 v33, s85, v33
    v_mul_f32 v34, s85, v34
    s_waitcnt vmcnt(1)
    s_add_u32 s49, s48, 393216
    s_sub_u32 s95, s49, 3145728
    s_min_u32 s49, s49, s95
    buffer_load_dwordx4 v[112:115], v3, s[32:35], s49 offen offset:0 nt
    s_waitcnt vmcnt(3)
    buffer_load_dwordx4 v[116:119], v3, s[32:35], s49 offen offset:128 nt
    s_waitcnt vmcnt(3)
    buffer_load_dwordx4 v[120:123], v3, s[32:35], s49 offen offset:256 nt
    v_exp_f32 v20, v20
    v_exp_f32 v21, v21
    v_exp_f32 v22, v22
    v_exp_f32 v23, v23
    v_exp_f32 v24, v24
    v_exp_f32 v25, v25
    v_exp_f32 v26, v26
    v_exp_f32 v27, v27
    v_exp_f32 v28, v28
    v_exp_f32 v29, v29
    v_exp_f32 v30, v30
    v_exp_f32 v31, v31
    v_exp_f32 v32, v32
    v_exp_f32 v33, v33
    v_exp_f32 v34, v34
    v_add_f32 v59, v20, v21
    v_add_f32 v59, v59, v22
    v_add_f32 v59, v59, v23
    v_add_f32 v59, v59, v24
    v_add_f32 v59, v59, v25
    v_add_f32 v59, v59, v26
    v_add_f32 v59, v59, v27
    v_add_f32 v59, v59, v28
    v_add_f32 v59, v59, v29
    v_add_f32 v59, v59, v30
    v_add_f32 v59, v59, v31
    v_add_f32 v59, v59, v32
    v_add_f32 v59, v59, v33
    v_add_f32 v59, v59, v34
    v_cvt_pk_bf16_f32 v20, v20, v20
    v_cvt_pk_bf16_f32 v21, v21, v21
    v_cvt_pk_bf16_f32 v22, v22, v22
    v_cvt_pk_bf16_f32 v23, v23, v23
    v_cvt_pk_bf16_f32 v24, v24, v24
    v_cvt_pk_bf16_f32 v25, v25, v25
    v_cvt_pk_bf16_f32 v26, v26, v26
    v_cvt_pk_bf16_f32 v27, v27, v27
    v_cvt_pk_bf16_f32 v28, v28, v28
    v_cvt_pk_bf16_f32 v29, v29, v29
    v_cvt_pk_bf16_f32 v30, v30, v30
    v_cvt_pk_bf16_f32 v31, v31, v31
    v_cvt_pk_bf16_f32 v32, v32, v32
    v_cvt_pk_bf16_f32 v33, v33, v33
    v_and_b32 v48, v20, v4
    v_and_b32 v49, v20, v5
    v_and_b32 v50, v20, v6
    v_and_b32 v51, v20, v7
    s_nop 1
    v_mfma_f32_16x16x32_bf16 v[36:39], v[88:91], v[48:51], 0
    v_mfma_f32_16x16x32_bf16 v[40:43], v[92:95], v[48:51], 0
    v_mfma_f32_16x16x32_bf16 v[44:47], v[96:99], v[48:51], 0
    s_waitcnt vmcnt(1)
    s_add_u32 s49, s48, 589824
    s_sub_u32 s95, s49, 3145728
    s_min_u32 s49, s49, s95
    buffer_load_dwordx4 v[124:127], v3, s[32:35], s49 offen offset:0 nt
    s_waitcnt vmcnt(3)
    buffer_load_dwordx4 v[128:131], v3, s[32:35], s49 offen offset:128 nt
    s_waitcnt vmcnt(3)
    buffer_load_dwordx4 v[132:135], v3, s[32:35], s49 offen offset:256 nt
    v_and_b32 v48, v21, v4
    v_and_b32 v49, v21, v5
    v_and_b32 v50, v21, v6
    v_and_b32 v51, v21, v7
    s_nop 1
    v_mfma_f32_16x16x32_bf16 v[36:39], v[100:103], v[48:51], v[36:39]
    v_mfma_f32_16x16x32_bf16 v[40:43], v[104:107], v[48:51], v[40:43]
    v_mfma_f32_16x16x32_bf16 v[44:47], v[108:111], v[48:51], v[44:47]
    s_waitcnt vmcnt(1)
    s_add_u32 s49, s48, 786432
    s_sub_u32 s95, s49, 3145728
    s_min_u32 s49, s49, s95
    buffer_load_dwordx4 v[88:91], v3, s[32:35], s49 offen offset:0 nt
    s_waitcnt vmcnt(3)
    buffer_load_dwordx4 v[92:95], v3, s[32:35], s49 offen offset:128 nt
    s_waitcnt vmcnt(3)
    buffer_load_dwordx4 v[96:99], v3, s[32:35], s49 offen offset:256 nt
    v_and_b32 v48, v22, v4
    v_and_b32 v49, v22, v5
    v_and_b32 v50, v22, v6
    v_and_b32 v51, v22, v7
    s_nop 1
    v_mfma_f32_16x16x32_bf16 v[36:39], v[112:115], v[48:51], v[36:39]
    v_mfma_f32_16x16x32_bf16 v[40:43], v[116:119], v[48:51], v[40:43]
    v_mfma_f32_16x16x32_bf16 v[44:47], v[120:123], v[48:51], v[44:47]
    s_waitcnt vmcnt(1)
    s_add_u32 s49, s48, 983040
    s_sub_u32 s95, s49, 3145728
    s_min_u32 s49, s49, s95
    buffer_load_dwordx4 v[100:103], v3, s[32:35], s49 offen offset:0 nt
    s_waitcnt vmcnt(3)
    buffer_load_dwordx4 v[104:107], v3, s[32:35], s49 offen offset:128 nt
    s_waitcnt vmcnt(3)
    buffer_load_dwordx4 v[108:111], v3, s[32:35], s49 offen offset:256 nt
    v_and_b32 v48, v23, v4
    v_and_b32 v49, v23, v5
    v_and_b32 v50, v23, v6
    v_and_b32 v51, v23, v7
    s_nop 1
    v_mfma_f32_16x16x32_bf16 v[36:39], v[124:127], v[48:51], v[36:39]
    v_mfma_f32_16x16x32_bf16 v[40:43], v[128:131], v[48:51], v[40:43]
    v_mfma_f32_16x16x32_bf16 v[44:47], v[132:135], v[48:51], v[44:47]
    s_waitcnt vmcnt(1)
    s_add_u32 s49, s48, 1179648
    s_sub_u32 s95, s49, 3145728
    s_min_u32 s49, s49, s95
    buffer_load_dwordx4 v[112:115], v3, s[32:35], s49 offen offset:0 nt
    s_waitcnt vmcnt(3)
    buffer_load_dwordx4 v[116:119], v3, s[32:35], s49 offen offset:128 nt
    s_waitcnt vmcnt(3)
    buffer_load_dwordx4 v[120:123], v3, s[32:35], s49 offen offset:256 nt
    v_and_b32 v48, v24, v4
    v_and_b32 v49, v24, v5
    v_and_b32 v50, v24, v6
    v_and_b32 v51, v24, v7
    s_nop 1
    v_mfma_f32_16x16x32_bf16 v[36:39], v[88:91], v[48:51], v[36:39]
    v_mfma_f32_16x16x32_bf16 v[40:43], v[92:95], v[48:51], v[40:43]
    v_mfma_f32_16x16x32_bf16 v[44:47], v[96:99], v[48:51], v[44:47]
    s_waitcnt vmcnt(1)
    s_add_u32 s49, s48, 1376256
    s_sub_u32 s95, s49, 3145728
    s_min_u32 s49, s49, s95
    buffer_load_dwordx4 v[124:127], v3, s[32:35], s49 offen offset:0 nt
    s_waitcnt vmcnt(3)
    buffer_load_dwordx4 v[128:131], v3, s[32:35], s49 offen offset:128 nt
    s_waitcnt vmcnt(3)
    buffer_load_dwordx4 v[132:135], v3, s[32:35], s49 offen offset:256 nt
    v_and_b32 v48, v25, v4
    v_and_b32 v49, v25, v5
    v_and_b32 v50, v25, v6
    v_and_b32 v51, v25, v7
    s_nop 1
    v_mfma_f32_16x16x32_bf16 v[36:39], v[100:103], v[48:51], v[36:39]
    v_mfma_f32_16x16x32_bf16 v[40:43], v[104:107], v[48:51], v[40:43]
    v_mfma_f32_16x16x32_bf16 v[44:47], v[108:111], v[48:51], v[44:47]
    s_waitcnt vmcnt(1)
    s_add_u32 s49, s48, 1572864
    s_sub_u32 s95, s49, 3145728
    s_min_u32 s49, s49, s95
    buffer_load_dwordx4 v[88:91], v3, s[32:35], s49 offen offset:0 nt
    s_waitcnt vmcnt(3)
    buffer_load_dwordx4 v[92:95], v3, s[32:35], s49 offen offset:128 nt
    s_waitcnt vmcnt(3)
    buffer_load_dwordx4 v[96:99], v3, s[32:35], s49 offen offset:256 nt
    v_and_b32 v48, v26, v4
    v_and_b32 v49, v26, v5
    v_and_b32 v50, v26, v6
    v_and_b32 v51, v26, v7
    s_nop 1
    v_mfma_f32_16x16x32_bf16 v[36:39], v[112:115], v[48:51], v[36:39]
    v_mfma_f32_16x16x32_bf16 v[40:43], v[116:119], v[48:51], v[40:43]
    v_mfma_f32_16x16x32_bf16 v[44:47], v[120:123], v[48:51], v[44:47]
    s_waitcnt vmcnt(1)
    s_add_u32 s49, s48, 1769472
    s_sub_u32 s95, s49, 3145728
    s_min_u32 s49, s49, s95
    buffer_load_dwordx4 v[100:103], v3, s[32:35], s49 offen offset:0 nt
    s_waitcnt vmcnt(3)
    buffer_load_dwordx4 v[104:107], v3, s[32:35], s49 offen offset:128 nt
    s_waitcnt vmcnt(3)
    buffer_load_dwordx4 v[108:111], v3, s[32:35], s49 offen offset:256 nt
    v_and_b32 v48, v27, v4
    v_and_b32 v49, v27, v5
    v_and_b32 v50, v27, v6
    v_and_b32 v51, v27, v7
    s_nop 1
    v_mfma_f32_16x16x32_bf16 v[36:39], v[124:127], v[48:51], v[36:39]
    v_mfma_f32_16x16x32_bf16 v[40:43], v[128:131], v[48:51], v[40:43]
    v_mfma_f32_16x16x32_bf16 v[44:47], v[132:135], v[48:51], v[44:47]
    s_waitcnt vmcnt(1)
    s_add_u32 s49, s48, 1966080
    s_sub_u32 s95, s49, 3145728
    s_min_u32 s49, s49, s95
    buffer_load_dwordx4 v[112:115], v3, s[32:35], s49 offen offset:0 nt
    s_waitcnt vmcnt(3)
    buffer_load_dwordx4 v[116:119], v3, s[32:35], s49 offen offset:128 nt
    s_waitcnt vmcnt(3)
    buffer_load_dwordx4 v[120:123], v3, s[32:35], s49 offen offset:256 nt
    v_and_b32 v48, v28, v4
    v_and_b32 v49, v28, v5
    v_and_b32 v50, v28, v6
    v_and_b32 v51, v28, v7
    s_nop 1
    v_mfma_f32_16x16x32_bf16 v[36:39], v[88:91], v[48:51], v[36:39]
    v_mfma_f32_16x16x32_bf16 v[40:43], v[92:95], v[48:51], v[40:43]
    v_mfma_f32_16x16x32_bf16 v[44:47], v[96:99], v[48:51], v[44:47]
    s_waitcnt vmcnt(1)
    s_add_u32 s49, s48, 2162688
    s_sub_u32 s95, s49, 3145728
    s_min_u32 s49, s49, s95
    buffer_load_dwordx4 v[124:127], v3, s[32:35], s49 offen offset:0 nt
    s_waitcnt vmcnt(3)
    buffer_load_dwordx4 v[128:131], v3, s[32:35], s49 offen offset:128 nt
    s_waitcnt vmcnt(3)
    buffer_load_dwordx4 v[132:135], v3, s[32:35], s49 offen offset:256 nt
    v_and_b32 v48, v29, v4
    v_and_b32 v49, v29, v5
    v_and_b32 v50, v29, v6
    v_and_b32 v51, v29, v7
    s_nop 1
    v_mfma_f32_16x16x32_bf16 v[36:39], v[100:103], v[48:51], v[36:39]
    v_mfma_f32_16x16x32_bf16 v[40:43], v[104:107], v[48:51], v[40:43]
    v_mfma_f32_16x16x32_bf16 v[44:47], v[108:111], v[48:51], v[44:47]
    s_waitcnt vmcnt(1)
    s_add_u32 s49, s48, 2359296
    s_sub_u32 s95, s49, 3145728
    s_min_u32 s49, s49, s95
    buffer_load_dwordx4 v[88:91], v3, s[32:35], s49 offen offset:0 nt
    s_waitcnt vmcnt(3)
    buffer_load_dwordx4 v[92:95], v3, s[32:35], s49 offen offset:128 nt
    s_waitcnt vmcnt(3)
    buffer_load_dwordx4 v[96:99], v3, s[32:35], s49 offen offset:256 nt
    v_and_b32 v48, v30, v4
    v_and_b32 v49, v30, v5
    v_and_b32 v50, v30, v6
    v_and_b32 v51, v30, v7
    s_nop 1
    v_mfma_f32_16x16x32_bf16 v[36:39], v[112:115], v[48:51], v[36:39]
    v_mfma_f32_16x16x32_bf16 v[40:43], v[116:119], v[48:51], v[40:43]
    v_mfma_f32_16x16x32_bf16 v[44:47], v[120:123], v[48:51], v[44:47]
    s_waitcnt vmcnt(1)
    s_add_u32 s49, s48, 2555904
    s_sub_u32 s95, s49, 3145728
    s_min_u32 s49, s49, s95
    buffer_load_dwordx4 v[100:103], v3, s[32:35], s49 offen offset:0 nt
    s_waitcnt vmcnt(3)
    buffer_load_dwordx4 v[104:107], v3, s[32:35], s49 offen offset:128 nt
    s_waitcnt vmcnt(3)
    buffer_load_dwordx4 v[108:111], v3, s[32:35], s49 offen offset:256 nt
    v_and_b32 v48, v31, v4
    v_and_b32 v49, v31, v5
    v_and_b32 v50, v31, v6
    v_and_b32 v51, v31, v7
    s_nop 1
    v_mfma_f32_16x16x32_bf16 v[36:39], v[124:127], v[48:51], v[36:39]
    v_mfma_f32_16x16x32_bf16 v[40:43], v[128:131], v[48:51], v[40:43]
    v_mfma_f32_16x16x32_bf16 v[44:47], v[132:135], v[48:51], v[44:47]
    s_waitcnt vmcnt(1)
    s_add_u32 s49, s48, 2752512
    s_sub_u32 s95, s49, 3145728
    s_min_u32 s49, s49, s95
    buffer_load_dwordx4 v[76:79], v3, s[32:35], s49 offen offset:0 nt
    s_waitcnt vmcnt(2)
    buffer_load_dwordx4 v[80:83], v3, s[32:35], s49 offen offset:128 nt
    s_waitcnt vmcnt(2)
    buffer_load_dwordx4 v[84:87], v3, s[32:35], s49 offen offset:256 nt
    v_and_b32 v48, v32, v4
    v_and_b32 v49, v32, v5
    v_and_b32 v50, v32, v6
    v_and_b32 v51, v32, v7
    s_nop 1
    v_mfma_f32_16x16x32_bf16 v[36:39], v[88:91], v[48:51], v[36:39]
    v_mfma_f32_16x16x32_bf16 v[40:43], v[92:95], v[48:51], v[40:43]
    v_mfma_f32_16x16x32_bf16 v[44:47], v[96:99], v[48:51], v[44:47]
    v_and_b32 v52, v33, v4
    v_and_b32 v53, v33, v5
    v_and_b32 v54, v33, v6
    v_and_b32 v55, v33, v7
    s_nop 1
    v_mfma_f32_16x16x32_bf16 v[36:39], v[100:103], v[52:55], v[36:39]
    v_mfma_f32_16x16x32_bf16 v[40:43], v[104:107], v[52:55], v[40:43]
    v_mfma_f32_16x16x32_bf16 v[44:47], v[108:111], v[52:55], v[44:47]
    s_cmp_lg_u32 s3, 0
    s_cbranch_scc1 L_ntk14
    s_mov_b32 s88, 8
    s_atomic_add s88, s[86:87], 0 glc
L_ntk14:
    v_mov_b32 v20, v34
    s_branch L_enter
L_st_wo:
    s_lshl_b32 s80, s55, 3
    s_add_u32 s80, s80, s3
    s_mul_i32 s80, s80, 122880
    s_lshl_b32 s81, s50, 7
    s_add_u32 s80, s80, s81
    s_add_u32 s40, s12, s80
    s_addc_u32 s41, s13, 0
    s_sub_u32 s42, 7864320, s80
    s_mov_b32 s43, 0x20000
    v_lshrrev_b32 v35, 2, v56
    v_mul_u32_u24 v35, 2560, v35
    v_and_b32 v60, 1, v56
    v_mul_u32_u24 v60, 1280, v60
    v_bfe_u32 v61, v56, 1, 1
    v_mul_u32_u24 v61, 10240, v61
    v_add3_u32 v35, v35, v60, v61
    v_lshl_add_u32 v35, v57, 4, v35
    s_mov_b32 s80, 40960
    buffer_load_dwordx4 v[224:227], v35, s[40:43], s80 offen nt
    s_waitcnt vmcnt(2)
    s_mov_b32 s80, 46080
    buffer_load_dwordx4 v[228:231], v35, s[40:43], s80 offen nt
    s_waitcnt vmcnt(2)
    s_mov_b32 s80, 61440
    buffer_load_dwordx4 v[232:235], v35, s[40:43], s80 offen nt
    v_mfma_f32_16x16x32_bf16 v[48:51], v[172:175], v[8:11], 0
    v_mfma_f32_16x16x32_bf16 v[48:51], v[176:179], v[12:15], v[48:51]
    v_mfma_f32_16x16x32_bf16 v[48:51], v[180:183], v[16:19], v[48:51]
    s_nop 7
    v_mov_b32_dpp v29, v48 quad_perm:[0,0,0,0] row_mask:0xf bank_mask:0xf
    v_add_f32_dpp v29, v49, v29 quad_perm:[1,1,1,1] row_mask:0xf bank_mask:0xf
    v_add_f32_dpp v29, v50, v29 quad_perm:[2,2,2,2] row_mask:0xf bank_mask:0xf
    v_add_f32_dpp v29, v51, v29 quad_perm:[3,3,3,3] row_mask:0xf bank_mask:0xf
    v_cvt_pk_bf16_f32 v29, v29, v29
    v_and_b32 v29, 0xffff0000, v29
    v_mul_f32 v29, s84, v29
    v_cvt_pk_bf16_f32 v29, v29, v29
    v_and_b32 v29, 0xffff0000, v29
    s_waitcnt vmcnt(2)
    s_mov_b32 s80, 66560
    buffer_load_dwordx4 v[236:239], v35, s[40:43], s80 offen nt
    s_waitcnt vmcnt(2)
    s_mov_b32 s80, 81920
    buffer_load_dwordx4 v[240:243], v35, s[40:43], s80 offen nt
    s_waitcnt vmcnt(2)
    s_mov_b32 s80, 87040
    buffer_load_dwordx4 v[244:247], v35, s[40:43], s80 offen nt
    s_waitcnt vmcnt(2)
    s_mov_b32 s80, 102400
    buffer_load_dwordx4 v[248:251], v35, s[40:43], s80 offen nt
    s_waitcnt vmcnt(2)
    s_mov_b32 s80, 107520
    buffer_load_dwordx4 v[252:255], v35, s[40:43], s80 offen nt
    s_waitcnt vmcnt(2)
    s_add_u32 s49, s48, 1966080
    s_sub_u32 s95, s49, 3145728
    s_min_u32 s49, s49, s95
    buffer_load_dwordx4 v[184:187], v2, s[28:31], s49 offen offset:0 nt
    s_waitcnt vmcnt(3)
    buffer_load_dwordx4 v[188:191], v2, s[28:31], s49 offen offset:128 nt
    s_waitcnt vmcnt(3)
    buffer_load_dwordx4 v[192:195], v2, s[28:31], s49 offen offset:256 nt
    s_waitcnt vmcnt(1)
    s_add_u32 s49, s48, 2162688
    s_sub_u32 s95, s49, 3145728
    s_min_u32 s49, s49, s95
    buffer_load_dwordx4 v[196:199], v2, s[28:31], s49 offen offset:0 nt
    s_cmp_lg_u32 s3, 0
    s_cbranch_scc1 L_nw15
    s_load_dword s88, s[24:25], 4 glc
L_nw15:
    s_waitcnt vmcnt(3)
    buffer_load_dwordx4 v[200:203], v2, s[28:31], s49 offen offset:128 nt
    s_waitcnt vmcnt(3)
    buffer_load_dwordx4 v[204:207], v2, s[28:31], s49 offen offset:256 nt
    s_waitcnt vmcnt(1)
    s_add_u32 s49, s48, 2359296
    s_sub_u32 s95, s49, 3145728
    s_min_u32 s49, s49, s95
    buffer_load_dwordx4 v[208:211], v2, s[28:31], s49 offen offset:0 nt
    v_mfma_f32_16x16x32_bf16 v[48:51], v[184:187], v[8:11], 0
    v_mfma_f32_16x16x32_bf16 v[48:51], v[188:191], v[12:15], v[48:51]
    v_mfma_f32_16x16x32_bf16 v[48:51], v[192:195], v[16:19], v[48:51]
    s_nop 7
    v_mov_b32_dpp v30, v48 quad_perm:[0,0,0,0] row_mask:0xf bank_mask:0xf
    v_add_f32_dpp v30, v49, v30 quad_perm:[1,1,1,1] row_mask:0xf bank_mask:0xf
    v_add_f32_dpp v30, v50, v30 quad_perm:[2,2,2,2] row_mask:0xf bank_mask:0xf
    v_add_f32_dpp v30, v51, v30 quad_perm:[3,3,3,3] row_mask:0xf bank_mask:0xf
    v_cvt_pk_bf16_f32 v30, v30, v30
    v_and_b32 v30, 0xffff0000, v30
    v_mul_f32 v30, s84, v30
    v_cvt_pk_bf16_f32 v30, v30, v30
    v_and_b32 v30, 0xffff0000, v30
    s_cmp_lg_u32 s3, 0
    s_cbranch_scc1 L_nw16
    s_mov_b32 s94, 1048576
L_ai17:
    s_waitcnt lgkmcnt(0)
    s_cmp_ge_u32 s88, 16
    s_cbranch_scc1 L_aio17
    s_sleep 8
    s_load_dword s88, s[24:25], 4 glc
    s_sub_u32 s94, s94, 1
    s_cmp_lg_u32 s94, 0
    s_cbranch_scc1 L_ai17
    s_waitcnt lgkmcnt(0)
L_aio17:
L_nw16:
    s_waitcnt vmcnt(3)
    buffer_load_dwordx4 v[212:215], v2, s[28:31], s49 offen offset:128 nt
    s_waitcnt vmcnt(3)
    buffer_load_dwordx4 v[216:219], v2, s[28:31], s49 offen offset:256 nt
    s_waitcnt vmcnt(1)
    s_add_u32 s49, s48, 0
    s_sub_u32 s95, s49, 3145728
    s_min_u32 s49, s49, s95
    buffer_load_dwordx4 v[88:91], v3, s[32:35], s49 offen offset:0 nt
    v_mfma_f32_16x16x32_bf16 v[48:51], v[196:199], v[8:11], 0
    v_mfma_f32_16x16x32_bf16 v[48:51], v[200:203], v[12:15], v[48:51]
    v_mfma_f32_16x16x32_bf16 v[48:51], v[204:207], v[16:19], v[48:51]
    s_nop 7
    v_mov_b32_dpp v31, v48 quad_perm:[0,0,0,0] row_mask:0xf bank_mask:0xf
    v_add_f32_dpp v31, v49, v31 quad_perm:[1,1,1,1] row_mask:0xf bank_mask:0xf
    v_add_f32_dpp v31, v50, v31 quad_perm:[2,2,2,2] row_mask:0xf bank_mask:0xf
    v_add_f32_dpp v31, v51, v31 quad_perm:[3,3,3,3] row_mask:0xf bank_mask:0xf
    v_cvt_pk_bf16_f32 v31, v31, v31
    v_and_b32 v31, 0xffff0000, v31
    v_mul_f32 v31, s84, v31
    v_cvt_pk_bf16_f32 v31, v31, v31
    v_and_b32 v31, 0xffff0000, v31
    s_waitcnt vmcnt(3)
    buffer_load_dwordx4 v[92:95], v3, s[32:35], s49 offen offset:128 nt
    s_waitcnt vmcnt(3)
    buffer_load_dwordx4 v[96:99], v3, s[32:35], s49 offen offset:256 nt
    s_waitcnt vmcnt(1)
    s_add_u32 s49, s48, 196608
    s_sub_u32 s95, s49, 3145728
    s_min_u32 s49, s49, s95
    buffer_load_dwordx4 v[100:103], v3, s[32:35], s49 offen offset:0 nt
    v_mfma_f32_16x16x32_bf16 v[48:51], v[208:211], v[8:11], 0
    v_mfma_f32_16x16x32_bf16 v[48:51], v[212:215], v[12:15], v[48:51]
    v_mfma_f32_16x16x32_bf16 v[48:51], v[216:219], v[16:19], v[48:51]
    s_nop 7
    v_mov_b32_dpp v32, v48 quad_perm:[0,0,0,0] row_mask:0xf bank_mask:0xf
    v_add_f32_dpp v32, v49, v32 quad_perm:[1,1,1,1] row_mask:0xf bank_mask:0xf
    v_add_f32_dpp v32, v50, v32 quad_perm:[2,2,2,2] row_mask:0xf bank_mask:0xf
    v_add_f32_dpp v32, v51, v32 quad_perm:[3,3,3,3] row_mask:0xf bank_mask:0xf
    v_cvt_pk_bf16_f32 v32, v32, v32
    v_and_b32 v32, 0xffff0000, v32
    v_mul_f32 v32, s84, v32
    v_cvt_pk_bf16_f32 v32, v32, v32
    v_and_b32 v32, 0xffff0000, v32
    v_max_f32 v58, v20, v21
    v_max3_f32 v58, v58, v22, v23
    v_max3_f32 v58, v58, v24, v25
    v_max3_f32 v58, v58, v26, v27
    v_max3_f32 v58, v58, v28, v29
    v_max3_f32 v58, v58, v30, v31
    v_max_f32 v58, v58, v32
    s_nop 1
    v_max_f32_dpp v58, v58, v58 row_ror:8 row_mask:0xf bank_mask:0xf
    s_nop 1
    v_max_f32_dpp v58, v58, v58 row_bcast:15 row_mask:0xa bank_mask:0xf
    s_nop 1
    v_max_f32_dpp v58, v58, v58 row_bcast:31 row_mask:0xc bank_mask:0xf
    s_nop 0
    v_readlane_b32 s80, v58, 63
    s_nop 1
    v_mov_b32 v58, s80
    v_sub_f32 v20, v20, v58
    v_sub_f32 v21, v21, v58
    v_sub_f32 v22, v22, v58
    v_sub_f32 v23, v23, v58
    v_sub_f32 v24, v24, v58
    v_sub_f32 v25, v25, v58
    v_sub_f32 v26, v26, v58
    v_sub_f32 v27, v27, v58
    v_sub_f32 v28, v28, v58
    v_sub_f32 v29, v29, v58
    v_sub_f32 v30, v30, v58
    v_sub_f32 v31, v31, v58
    v_sub_f32 v32, v32, v58
    v_mul_f32 v20, s85, v20
    v_mul_f32 v21, s85, v21
    v_mul_f32 v22, s85, v22
    v_mul_f32 v23, s85, v23
    v_mul_f32 v24, s85, v24
    v_mul_f32 v25, s85, v25
    v_mul_f32 v26, s85, v26
    v_mul_f32 v27, s85, v27
    v_mul_f32 v28, s85, v28
    v_mul_f32 v29, s85, v29
    v_mul_f32 v30, s85, v30
    v_mul_f32 v31, s85, v31
    v_mul_f32 v32, s85, v32
    s_waitcnt vmcnt(3)
    buffer_load_dwordx4 v[104:107], v3, s[32:35], s49 offen offset:128 nt
    s_waitcnt vmcnt(3)
    buffer_load_dwordx4 v[108:111], v3, s[32:35], s49 offen offset:256 nt
    s_waitcnt vmcnt(1)
    s_add_u32 s49, s48, 393216
    s_sub_u32 s95, s49, 3145728
    s_min_u32 s49, s49, s95
    buffer_load_dwordx4 v[112:115], v3, s[32:35], s49 offen offset:0 nt
    v_exp_f32 v20, v20
    v_exp_f32 v21, v21
    v_exp_f32 v22, v22
    v_exp_f32 v23, v23
    v_exp_f32 v24, v24
    v_exp_f32 v25, v25
    v_exp_f32 v26, v26
    v_exp_f32 v27, v27
    v_exp_f32 v28, v28
    v_exp_f32 v29, v29
    v_exp_f32 v30, v30
    v_exp_f32 v31, v31
    v_exp_f32 v32, v32
    v_add_f32 v59, v20, v21
    v_add_f32 v59, v59, v22
    v_add_f32 v59, v59, v23
    v_add_f32 v59, v59, v24
    v_add_f32 v59, v59, v25
    v_add_f32 v59, v59, v26
    v_add_f32 v59, v59, v27
    v_add_f32 v59, v59, v28
    v_add_f32 v59, v59, v29
    v_add_f32 v59, v59, v30
    v_add_f32 v59, v59, v31
    v_add_f32 v59, v59, v32
    v_cvt_pk_bf16_f32 v20, v20, v20
    v_cvt_pk_bf16_f32 v21, v21, v21
    v_cvt_pk_bf16_f32 v22, v22, v22
    v_cvt_pk_bf16_f32 v23, v23, v23
    v_cvt_pk_bf16_f32 v24, v24, v24
    v_cvt_pk_bf16_f32 v25, v25, v25
    v_cvt_pk_bf16_f32 v26, v26, v26
    v_cvt_pk_bf16_f32 v27, v27, v27
    v_cvt_pk_bf16_f32 v28, v28, v28
    v_cvt_pk_bf16_f32 v29, v29, v29
    v_cvt_pk_bf16_f32 v30, v30, v30
    v_cvt_pk_bf16_f32 v31, v31, v31
    v_and_b32 v48, v20, v4
    v_and_b32 v49, v20, v5
    v_and_b32 v50, v20, v6
    v_and_b32 v51, v20, v7
    s_nop 1
    v_mfma_f32_16x16x32_bf16 v[36:39], v[88:91], v[48:51], 0
    v_mfma_f32_16x16x32_bf16 v[40:43], v[92:95], v[48:51], 0
    v_mfma_f32_16x16x32_bf16 v[44:47], v[96:99], v[48:51], 0
    s_waitcnt vmcnt(3)
    buffer_load_dwordx4 v[116:119], v3, s[32:35], s49 offen offset:128 nt
    s_waitcnt vmcnt(3)
    buffer_load_dwordx4 v[120:123], v3, s[32:35], s49 offen offset:256 nt
    s_waitcnt vmcnt(1)
    s_add_u32 s49, s48, 589824
    s_sub_u32 s95, s49, 3145728
    s_min_u32 s49, s49, s95
    buffer_load_dwordx4 v[124:127], v3, s[32:35], s49 offen offset:0 nt
    v_and_b32 v48, v21, v4
    v_and_b32 v49, v21, v5
    v_and_b32 v50, v21, v6
    v_and_b32 v51, v21, v7
    s_nop 1
    v_mfma_f32_16x16x32_bf16 v[36:39], v[100:103], v[48:51], v[36:39]
    v_mfma_f32_16x16x32_bf16 v[40:43], v[104:107], v[48:51], v[40:43]
    v_mfma_f32_16x16x32_bf16 v[44:47], v[108:111], v[48:51], v[44:47]
    s_waitcnt vmcnt(3)
    buffer_load_dwordx4 v[128:131], v3, s[32:35], s49 offen offset:128 nt
    s_waitcnt vmcnt(3)
    buffer_load_dwordx4 v[132:135], v3, s[32:35], s49 offen offset:256 nt
    s_waitcnt vmcnt(1)
    s_add_u32 s49, s48, 786432
    s_sub_u32 s95, s49, 3145728
    s_min_u32 s49, s49, s95
    buffer_load_dwordx4 v[88:91], v3, s[32:35], s49 offen offset:0 nt
    v_and_b32 v48, v22, v4
    v_and_b32 v49, v22, v5
    v_and_b32 v50, v22, v6
    v_and_b32 v51, v22, v7
    s_nop 1
    v_mfma_f32_16x16x32_bf16 v[36:39], v[112:115], v[48:51], v[36:39]
    v_mfma_f32_16x16x32_bf16 v[40:43], v[116:119], v[48:51], v[40:43]
    v_mfma_f32_16x16x32_bf16 v[44:47], v[120:123], v[48:51], v[44:47]
    s_waitcnt vmcnt(3)
    buffer_load_dwordx4 v[92:95], v3, s[32:35], s49 offen offset:128 nt
    s_waitcnt vmcnt(3)
    buffer_load_dwordx4 v[96:99], v3, s[32:35], s49 offen offset:256 nt
    s_waitcnt vmcnt(1)
    s_add_u32 s49, s48, 983040
    s_sub_u32 s95, s49, 3145728
    s_min_u32 s49, s49, s95
    buffer_load_dwordx4 v[100:103], v3, s[32:35], s49 offen offset:0 nt
    v_and_b32 v48, v23, v4
    v_and_b32 v49, v23, v5
    v_and_b32 v50, v23, v6
    v_and_b32 v51, v23, v7
    s_nop 1
    v_mfma_f32_16x16x32_bf16 v[36:39], v[124:127], v[48:51], v[36:39]
    v_mfma_f32_16x16x32_bf16 v[40:43], v[128:131], v[48:51], v[40:43]
    v_mfma_f32_16x16x32_bf16 v[44:47], v[132:135], v[48:51], v[44:47]
    s_waitcnt vmcnt(3)
    buffer_load_dwordx4 v[104:107], v3, s[32:35], s49 offen offset:128 nt
    s_waitcnt vmcnt(3)
    buffer_load_dwordx4 v[108:111], v3, s[32:35], s49 offen offset:256 nt
    s_waitcnt vmcnt(1)
    s_add_u32 s49, s48, 1179648
    s_sub_u32 s95, s49, 3145728
    s_min_u32 s49, s49, s95
    buffer_load_dwordx4 v[112:115], v3, s[32:35], s49 offen offset:0 nt
    v_and_b32 v48, v24, v4
    v_and_b32 v49, v24, v5
    v_and_b32 v50, v24, v6
    v_and_b32 v51, v24, v7
    s_nop 1
    v_mfma_f32_16x16x32_bf16 v[36:39], v[88:91], v[48:51], v[36:39]
    v_mfma_f32_16x16x32_bf16 v[40:43], v[92:95], v[48:51], v[40:43]
    v_mfma_f32_16x16x32_bf16 v[44:47], v[96:99], v[48:51], v[44:47]
    s_waitcnt vmcnt(3)
    buffer_load_dwordx4 v[116:119], v3, s[32:35], s49 offen offset:128 nt
    s_waitcnt vmcnt(3)
    buffer_load_dwordx4 v[120:123], v3, s[32:35], s49 offen offset:256 nt
    s_waitcnt vmcnt(1)
    s_add_u32 s49, s48, 1376256
    s_sub_u32 s95, s49, 3145728
    s_min_u32 s49, s49, s95
    buffer_load_dwordx4 v[124:127], v3, s[32:35], s49 offen offset:0 nt
    v_and_b32 v48, v25, v4
    v_and_b32 v49, v25, v5
    v_and_b32 v50, v25, v6
    v_and_b32 v51, v25, v7
    s_nop 1
    v_mfma_f32_16x16x32_bf16 v[36:39], v[100:103], v[48:51], v[36:39]
    v_mfma_f32_16x16x32_bf16 v[40:43], v[104:107], v[48:51], v[40:43]
    v_mfma_f32_16x16x32_bf16 v[44:47], v[108:111], v[48:51], v[44:47]
    s_waitcnt vmcnt(3)
    buffer_load_dwordx4 v[128:131], v3, s[32:35], s49 offen offset:128 nt
    s_waitcnt vmcnt(3)
    buffer_load_dwordx4 v[132:135], v3, s[32:35], s49 offen offset:256 nt
    s_waitcnt vmcnt(1)
    s_add_u32 s49, s48, 1572864
    s_sub_u32 s95, s49, 3145728
    s_min_u32 s49, s49, s95
    buffer_load_dwordx4 v[88:91], v3, s[32:35], s49 offen offset:0 nt
    v_and_b32 v48, v26, v4
    v_and_b32 v49, v26, v5
    v_and_b32 v50, v26, v6
    v_and_b32 v51, v26, v7
    s_nop 1
    v_mfma_f32_16x16x32_bf16 v[36:39], v[112:115], v[48:51], v[36:39]
    v_mfma_f32_16x16x32_bf16 v[40:43], v[116:119], v[48:51], v[40:43]
    v_mfma_f32_16x16x32_bf16 v[44:47], v[120:123], v[48:51], v[44:47]
    s_waitcnt vmcnt(3)
    buffer_load_dwordx4 v[92:95], v3, s[32:35], s49 offen offset:128 nt
    s_waitcnt vmcnt(3)
    buffer_load_dwordx4 v[96:99], v3, s[32:35], s49 offen offset:256 nt
    s_waitcnt vmcnt(1)
    s_add_u32 s49, s48, 1769472
    s_sub_u32 s95, s49, 3145728
    s_min_u32 s49, s49, s95
    buffer_load_dwordx4 v[100:103], v3, s[32:35], s49 offen offset:0 nt
    v_and_b32 v48, v27, v4
    v_and_b32 v49, v27, v5
    v_and_b32 v50, v27, v6
    v_and_b32 v51, v27, v7
    s_nop 1
    v_mfma_f32_16x16x32_bf16 v[36:39], v[124:127], v[48:51], v[36:39]
    v_mfma_f32_16x16x32_bf16 v[40:43], v[128:131], v[48:51], v[40:43]
    v_mfma_f32_16x16x32_bf16 v[44:47], v[132:135], v[48:51], v[44:47]
    s_waitcnt vmcnt(3)
    buffer_load_dwordx4 v[104:107], v3, s[32:35], s49 offen offset:128 nt
    s_waitcnt vmcnt(3)
    buffer_load_dwordx4 v[108:111], v3, s[32:35], s49 offen offset:256 nt
    s_waitcnt vmcnt(1)
    s_add_u32 s49, s48, 1966080
    s_sub_u32 s95, s49, 3145728
    s_min_u32 s49, s49, s95
    buffer_load_dwordx4 v[112:115], v3, s[32:35], s49 offen offset:0 nt
    v_and_b32 v48, v28, v4
    v_and_b32 v49, v28, v5
    v_and_b32 v50, v28, v6
    v_and_b32 v51, v28, v7
    s_nop 1
    v_mfma_f32_16x16x32_bf16 v[36:39], v[88:91], v[48:51], v[36:39]
    v_mfma_f32_16x16x32_bf16 v[40:43], v[92:95], v[48:51], v[40:43]
    v_mfma_f32_16x16x32_bf16 v[44:47], v[96:99], v[48:51], v[44:47]
    s_waitcnt vmcnt(3)
    buffer_load_dwordx4 v[116:119], v3, s[32:35], s49 offen offset:128 nt
    s_waitcnt vmcnt(3)
    buffer_load_dwordx4 v[120:123], v3, s[32:35], s49 offen offset:256 nt
    s_waitcnt vmcnt(1)
    s_add_u32 s49, s48, 2162688
    s_sub_u32 s95, s49, 3145728
    s_min_u32 s49, s49, s95
    buffer_load_dwordx4 v[124:127], v3, s[32:35], s49 offen offset:0 nt
    v_and_b32 v48, v29, v4
    v_and_b32 v49, v29, v5
    v_and_b32 v50, v29, v6
    v_and_b32 v51, v29, v7
    s_nop 1
    v_mfma_f32_16x16x32_bf16 v[36:39], v[100:103], v[48:51], v[36:39]
    v_mfma_f32_16x16x32_bf16 v[40:43], v[104:107], v[48:51], v[40:43]
    v_mfma_f32_16x16x32_bf16 v[44:47], v[108:111], v[48:51], v[44:47]
    s_waitcnt vmcnt(3)
    buffer_load_dwordx4 v[128:131], v3, s[32:35], s49 offen offset:128 nt
    s_waitcnt vmcnt(3)
    buffer_load_dwordx4 v[132:135], v3, s[32:35], s49 offen offset:256 nt
    s_waitcnt vmcnt(1)
    s_add_u32 s49, s48, 2359296
    s_sub_u32 s95, s49, 3145728
    s_min_u32 s49, s49, s95
    buffer_load_dwordx4 v[76:79], v3, s[32:35], s49 offen offset:0 nt
    v_and_b32 v48, v30, v4
    v_and_b32 v49, v30, v5
    v_and_b32 v50, v30, v6
    v_and_b32 v51, v30, v7
    s_nop 1
    v_mfma_f32_16x16x32_bf16 v[36:39], v[112:115], v[48:51], v[36:39]
    v_mfma_f32_16x16x32_bf16 v[40:43], v[116:119], v[48:51], v[40:43]
    v_mfma_f32_16x16x32_bf16 v[44:47], v[120:123], v[48:51], v[44:47]
    s_waitcnt vmcnt(2)
    buffer_load_dwordx4 v[80:83], v3, s[32:35], s49 offen offset:128 nt
    s_waitcnt vmcnt(2)
    buffer_load_dwordx4 v[84:87], v3, s[32:35], s49 offen offset:256 nt
    v_and_b32 v48, v31, v4
    v_and_b32 v49, v31, v5
    v_and_b32 v50, v31, v6
    v_and_b32 v51, v31, v7
    s_nop 1
    v_mfma_f32_16x16x32_bf16 v[36:39], v[124:127], v[48:51], v[36:39]
    v_mfma_f32_16x16x32_bf16 v[40:43], v[128:131], v[48:51], v[40:43]
    v_mfma_f32_16x16x32_bf16 v[44:47], v[132:135], v[48:51], v[44:47]
    s_cmp_lg_u32 s3, 0
    s_cbranch_scc1 L_ntk18
    s_mov_b32 s88, 8
    s_atomic_add s88, s[86:87], 0 glc
L_ntk18:
    v_mov_b32 v20, v32
    s_branch L_enter_wo
L_st_ffn:
    s_mul_i32 s80, s3, 245760
    s_lshl_b32 s81, s50, 7
    s_add_u32 s80, s80, s81
    s_add_u32 s40, s16, s80
    s_addc_u32 s41, s17, 0
    s_sub_u32 s42, 1966080, s80
    s_mov_b32 s43, 0x20000
    s_add_u32 s44, s18, s80
    s_addc_u32 s45, s19, 0
    s_sub_u32 s46, 1966080, s80
    s_mov_b32 s47, 0x20000
    v_lshrrev_b32 v35, 2, v56
    v_mul_u32_u24 v35, 61440, v35
    v_and_b32 v60, 1, v56
    v_mul_u32_u24 v60, 30720, v60
    v_bfe_u32 v61, v56, 1, 1
    v_mul_u32_u24 v61, 3072, v61
    v_add3_u32 v35, v35, v60, v61
    v_lshl_add_u32 v35, v57, 4, v35
    s_mov_b32 s80, 6144
    buffer_load_dwordx4 v[184:187], v35, s[40:43], s80 offen nt
    s_waitcnt vmcnt(2)
    s_mov_b32 s80, 129024
    buffer_load_dwordx4 v[188:191], v35, s[40:43], s80 offen nt
    s_waitcnt vmcnt(2)
    s_mov_b32 s80, 12288
    buffer_load_dwordx4 v[192:195], v35, s[40:43], s80 offen nt
    v_mfma_f32_16x16x32_bf16 v[48:51], v[172:175], v[8:11], 0
    v_mfma_f32_16x16x32_bf16 v[48:51], v[176:179], v[12:15], v[48:51]
    v_mfma_f32_16x16x32_bf16 v[48:51], v[180:183], v[16:19], v[48:51]
    s_nop 7
    v_mov_b32_dpp v29, v48 quad_perm:[0,0,0,0] row_mask:0xf bank_mask:0xf
    v_add_f32_dpp v29, v49, v29 quad_perm:[1,1,1,1] row_mask:0xf bank_mask:0xf
    v_add_f32_dpp v29, v50, v29 quad_perm:[2,2,2,2] row_mask:0xf bank_mask:0xf
    v_add_f32_dpp v29, v51, v29 quad_perm:[3,3,3,3] row_mask:0xf bank_mask:0xf
    v_cvt_pk_bf16_f32 v29, v29, v29
    v_and_b32 v29, 0xffff0000, v29
    v_mul_f32 v29, s84, v29
    v_cvt_pk_bf16_f32 v29, v29, v29
    v_and_b32 v29, 0xffff0000, v29
    v_max_f32 v58, v20, v21
    v_max3_f32 v58, v58, v22, v23
    v_max3_f32 v58, v58, v24, v25
    v_max3_f32 v58, v58, v26, v27
    v_max3_f32 v58, v58, v28, v29
    s_nop 1
    v_max_f32_dpp v58, v58, v58 row_ror:8 row_mask:0xf bank_mask:0xf
    s_nop 1
    v_max_f32_dpp v58, v58, v58 row_bcast:15 row_mask:0xa bank_mask:0xf
    s_nop 1
    v_max_f32_dpp v58, v58, v58 row_bcast:31 row_mask:0xc bank_mask:0xf
    s_nop 0
    v_readlane_b32 s80, v58, 63
    s_nop 1
    v_mov_b32 v58, s80
    v_sub_f32 v20, v20, v58
    v_sub_f32 v21, v21, v58
    v_sub_f32 v22, v22, v58
    v_sub_f32 v23, v23, v58
    v_sub_f32 v24, v24, v58
    v_sub_f32 v25, v25, v58
    v_sub_f32 v26, v26, v58
    v_sub_f32 v27, v27, v58
    v_sub_f32 v28, v28, v58
    v_sub_f32 v29, v29, v58
    v_mul_f32 v20, s85, v20
    v_mul_f32 v21, s85, v21
    v_mul_f32 v22, s85, v22
    v_mul_f32 v23, s85, v23
    v_mul_f32 v24, s85, v24
    v_mul_f32 v25, s85, v25
    v_mul_f32 v26, s85, v26
    v_mul_f32 v27, s85, v27
    v_mul_f32 v28, s85, v28
    v_mul_f32 v29, s85, v29
    s_waitcnt vmcnt(2)
    s_mov_b32 s80, 135168
    buffer_load_dwordx4 v[196:199], v35, s[40:43], s80 offen nt
    s_waitcnt vmcnt(2)
    s_mov_b32 s80, 18432
    buffer_load_dwordx4 v[200:203], v35, s[40:43], s80 offen nt
    s_waitcnt vmcnt(2)
    s_mov_b32 s80, 141312
    buffer_load_dwordx4 v[204:207], v35, s[40:43], s80 offen nt
    v_exp_f32 v20, v20
    v_exp_f32 v21, v21
    v_exp_f32 v22, v22
    v_exp_f32 v23, v23
    v_exp_f32 v24, v24
    v_exp_f32 v25, v25
    v_exp_f32 v26, v26
    v_exp_f32 v27, v27
    v_exp_f32 v28, v28
    v_exp_f32 v29, v29
    v_add_f32 v59, v20, v21
    v_add_f32 v59, v59, v22
    v_add_f32 v59, v59, v23
    v_add_f32 v59, v59, v24
    v_add_f32 v59, v59, v25
    v_add_f32 v59, v59, v26
    v_add_f32 v59, v59, v27
    v_add_f32 v59, v59, v28
    v_add_f32 v59, v59, v29
    v_cvt_pk_bf16_f32 v20, v20, v20
    v_cvt_pk_bf16_f32 v21, v21, v21
    v_cvt_pk_bf16_f32 v22, v22, v22
    v_cvt_pk_bf16_f32 v23, v23, v23
    v_cvt_pk_bf16_f32 v24, v24, v24
    v_cvt_pk_bf16_f32 v25, v25, v25
    v_cvt_pk_bf16_f32 v26, v26, v26
    v_cvt_pk_bf16_f32 v27, v27, v27
    v_cvt_pk_bf16_f32 v28, v28, v28
    s_waitcnt vmcnt(2)
    s_mov_b32 s80, 24576
    buffer_load_dwordx4 v[208:211], v35, s[40:43], s80 offen nt
    s_waitcnt vmcnt(2)
    s_mov_b32 s80, 147456
    buffer_load_dwordx4 v[212:215], v35, s[40:43], s80 offen nt
    s_waitcnt vmcnt(2)
    s_mov_b32 s80, 0
    buffer_load_dwordx4 v[216:219], v35, s[44:47], s80 offen nt
    s_waitcnt vmcnt(2)
    s_mov_b32 s80, 122880
    buffer_load_dwordx4 v[220:223], v35, s[44:47], s80 offen nt
    s_waitcnt vmcnt(2)
    s_mov_b32 s80, 6144
    buffer_load_dwordx4 v[224:227], v35, s[44:47], s80 offen nt
    s_waitcnt vmcnt(2)
    s_mov_b32 s80, 129024
    buffer_load_dwordx4 v[228:231], v35, s[44:47], s80 offen nt
    s_cmp_lg_u32 s3, 0
    s_cbranch_scc1 L_nw19
    s_load_dword s88, s[24:25], 4 glc
L_nw19:
    s_waitcnt vmcnt(2)
    s_mov_b32 s80, 12288
    buffer_load_dwordx4 v[232:235], v35, s[44:47], s80 offen nt
    s_waitcnt vmcnt(2)
    s_mov_b32 s80, 135168
    buffer_load_dwordx4 v[236:239], v35, s[44:47], s80 offen nt
    s_waitcnt vmcnt(2)
    s_mov_b32 s80, 18432
    buffer_load_dwordx4 v[240:243], v35, s[44:47], s80 offen nt
    s_cmp_lg_u32 s3, 0
    s_cbranch_scc1 L_nw20
    s_mov_b32 s94, 1048576
L_ai21:
    s_waitcnt lgkmcnt(0)
    s_cmp_ge_u32 s88, 16
    s_cbranch_scc1 L_aio21
    s_sleep 8
    s_load_dword s88, s[24:25], 4 glc
    s_sub_u32 s94, s94, 1
    s_cmp_lg_u32 s94, 0
    s_cbranch_scc1 L_ai21
    s_waitcnt lgkmcnt(0)
L_aio21:
L_nw20:
    s_waitcnt vmcnt(2)
    s_mov_b32 s80, 141312
    buffer_load_dwordx4 v[244:247], v35, s[44:47], s80 offen nt
    s_waitcnt vmcnt(2)
    s_mov_b32 s80, 24576
    buffer_load_dwordx4 v[248:251], v35, s[44:47], s80 offen nt
    s_waitcnt vmcnt(2)
    s_mov_b32 s80, 147456
    buffer_load_dwordx4 v[252:255], v35, s[44:47], s80 offen nt
    s_waitcnt vmcnt(2)
    s_mov_b32 s80, 0
    buffer_load_dwordx4 v[176:179], v35, s[40:43], s80 offen nt
    s_waitcnt vmcnt(2)
    s_mov_b32 s80, 122880
    buffer_load_dwordx4 v[180:183], v35, s[40:43], s80 offen nt
    s_waitcnt vmcnt(2)
    s_cmp_ge_u32 s3, 4
    s_cbranch_scc1 L_nodne
    s_mul_i32 s80, s50, 81920
    s_lshl_b32 s81, s3, 8
    s_add_u32 s80, s80, s81
    s_add_u32 s72, s20, s80
    s_addc_u32 s73, s21, 0
    s_sub_u32 s74, 1966080, s80
    s_mov_b32 s75, 0x20000
    v_lshrrev_b32 v35, 2, v56
    v_mul_u32_u24 v35, 40960, v35
    v_and_b32 v60, 1, v56
    v_mul_u32_u24 v60, 20480, v60
    v_bfe_u32 v61, v56, 1, 1
    v_mul_u32_u24 v61, 1280, v61
    v_add3_u32 v35, v35, v60, v61
    v_lshl_add_u32 v35, v57, 4, v35
    s_mov_b32 s80, 10240
    buffer_load_dwordx4 v[160:163], v35, s[72:75], s80 offen offset:128 nt
    s_waitcnt vmcnt(5)
    s_mov_b32 s80, 15360
    buffer_load_dwordx4 v[164:167], v35, s[72:75], s80 offen offset:128 nt
    s_waitcnt vmcnt(5)
    s_mov_b32 s80, 12800
    buffer_load_dwordx4 v[168:171], v35, s[72:75], s80 offen offset:128 nt
    s_waitcnt vmcnt(5)
    s_mov_b32 s80, 17920
    buffer_load_dwordx4 v[172:175], v35, s[72:75], s80 offen offset:128 nt
    s_waitcnt vmcnt(5)
    s_waitcnt vmcnt(2)
L_nodne:
    s_add_u32 s49, s48, 0
    s_sub_u32 s95, s49, 3145728
    s_min_u32 s49, s49, s95
    buffer_load_dwordx4 v[88:91], v3, s[32:35], s49 offen offset:0 nt
    s_waitcnt vmcnt(3)
    buffer_load_dwordx4 v[92:95], v3, s[32:35], s49 offen offset:128 nt
    s_waitcnt vmcnt(3)
    buffer_load_dwordx4 v[96:99], v3, s[32:35], s49 offen offset:256 nt
    s_waitcnt vmcnt(1)
    s_add_u32 s49, s48, 196608
    s_sub_u32 s95, s49, 3145728
    s_min_u32 s49, s49, s95
    buffer_load_dwordx4 v[100:103], v3, s[32:35], s49 offen offset:0 nt
    s_waitcnt vmcnt(3)
    buffer_load_dwordx4 v[104:107], v3, s[32:35], s49 offen offset:128 nt
    s_waitcnt vmcnt(3)
    buffer_load_dwordx4 v[108:111], v3, s[32:35], s49 offen offset:256 nt
    s_waitcnt vmcnt(1)
    s_add_u32 s49, s48, 393216
    s_sub_u32 s95, s49, 3145728
    s_min_u32 s49, s49, s95
    buffer_load_dwordx4 v[112:115], v3, s[32:35], s49 offen offset:0 nt
    v_and_b32 v48, v20, v4
    v_and_b32 v49, v20, v5
    v_and_b32 v50, v20, v6
    v_and_b32 v51, v20, v7
    s_nop 1
    v_mfma_f32_16x16x32_bf16 v[36:39], v[88:91], v[48:51], 0
    v_mfma_f32_16x16x32_bf16 v[40:43], v[92:95], v[48:51], 0
    v_mfma_f32_16x16x32_bf16 v[44:47], v[96:99], v[48:51], 0
    s_waitcnt vmcnt(3)
    buffer_load_dwordx4 v[116:119], v3, s[32:35], s49 offen offset:128 nt
    s_waitcnt vmcnt(3)
    buffer_load_dwordx4 v[120:123], v3, s[32:35], s49 offen offset:256 nt
    s_waitcnt vmcnt(1)
    s_add_u32 s49, s48, 589824
    s_sub_u32 s95, s49, 3145728
    s_min_u32 s49, s49, s95
    buffer_load_dwordx4 v[124:127], v3, s[32:35], s49 offen offset:0 nt
    v_and_b32 v48, v21, v4
    v_and_b32 v49, v21, v5
    v_and_b32 v50, v21, v6
    v_and_b32 v51, v21, v7
    s_nop 1
    v_mfma_f32_16x16x32_bf16 v[36:39], v[100:103], v[48:51], v[36:39]
    v_mfma_f32_16x16x32_bf16 v[40:43], v[104:107], v[48:51], v[40:43]
    v_mfma_f32_16x16x32_bf16 v[44:47], v[108:111], v[48:51], v[44:47]
    s_waitcnt vmcnt(3)
    buffer_load_dwordx4 v[128:131], v3, s[32:35], s49 offen offset:128 nt
    s_waitcnt vmcnt(3)
    buffer_load_dwordx4 v[132:135], v3, s[32:35], s49 offen offset:256 nt
    s_waitcnt vmcnt(1)
    s_add_u32 s49, s48, 786432
    s_sub_u32 s95, s49, 3145728
    s_min_u32 s49, s49, s95
    buffer_load_dwordx4 v[88:91], v3, s[32:35], s49 offen offset:0 nt
    v_and_b32 v48, v22, v4
    v_and_b32 v49, v22, v5
    v_and_b32 v50, v22, v6
    v_and_b32 v51, v22, v7
    s_nop 1
    v_mfma_f32_16x16x32_bf16 v[36:39], v[112:115], v[48:51], v[36:39]
    v_mfma_f32_16x16x32_bf16 v[40:43], v[116:119], v[48:51], v[40:43]
    v_mfma_f32_16x16x32_bf16 v[44:47], v[120:123], v[48:51], v[44:47]
    s_waitcnt vmcnt(3)
    buffer_load_dwordx4 v[92:95], v3, s[32:35], s49 offen offset:128 nt
    s_waitcnt vmcnt(3)
    buffer_load_dwordx4 v[96:99], v3, s[32:35], s49 offen offset:256 nt
    s_waitcnt vmcnt(1)
    s_add_u32 s49, s48, 983040
    s_sub_u32 s95, s49, 3145728
    s_min_u32 s49, s49, s95
    buffer_load_dwordx4 v[100:103], v3, s[32:35], s49 offen offset:0 nt
    v_and_b32 v48, v23, v4
    v_and_b32 v49, v23, v5
    v_and_b32 v50, v23, v6
    v_and_b32 v51, v23, v7
    s_nop 1
    v_mfma_f32_16x16x32_bf16 v[36:39], v[124:127], v[48:51], v[36:39]
    v_mfma_f32_16x16x32_bf16 v[40:43], v[128:131], v[48:51], v[40:43]
    v_mfma_f32_16x16x32_bf16 v[44:47], v[132:135], v[48:51], v[44:47]
    s_waitcnt vmcnt(3)
    buffer_load_dwordx4 v[104:107], v3, s[32:35], s49 offen offset:128 nt
    s_waitcnt vmcnt(3)
    buffer_load_dwordx4 v[108:111], v3, s[32:35], s49 offen offset:256 nt
    s_waitcnt vmcnt(1)
    s_add_u32 s49, s48, 1179648
    s_sub_u32 s95, s49, 3145728
    s_min_u32 s49, s49, s95
    buffer_load_dwordx4 v[112:115], v3, s[32:35], s49 offen offset:0 nt
    v_and_b32 v48, v24, v4
    v_and_b32 v49, v24, v5
    v_and_b32 v50, v24, v6
    v_and_b32 v51, v24, v7
    s_nop 1
    v_mfma_f32_16x16x32_bf16 v[36:39], v[88:91], v[48:51], v[36:39]
    v_mfma_f32_16x16x32_bf16 v[40:43], v[92:95], v[48:51], v[40:43]
    v_mfma_f32_16x16x32_bf16 v[44:47], v[96:99], v[48:51], v[44:47]
    s_waitcnt vmcnt(3)
    buffer_load_dwordx4 v[116:119], v3, s[32:35], s49 offen offset:128 nt
    s_waitcnt vmcnt(3)
    buffer_load_dwordx4 v[120:123], v3, s[32:35], s49 offen offset:256 nt
    s_waitcnt vmcnt(1)
    s_add_u32 s49, s48, 1376256
    s_sub_u32 s95, s49, 3145728
    s_min_u32 s49, s49, s95
    buffer_load_dwordx4 v[124:127], v3, s[32:35], s49 offen offset:0 nt
    v_and_b32 v48, v25, v4
    v_and_b32 v49, v25, v5
    v_and_b32 v50, v25, v6
    v_and_b32 v51, v25, v7
    s_nop 1
    v_mfma_f32_16x16x32_bf16 v[36:39], v[100:103], v[48:51], v[36:39]
    v_mfma_f32_16x16x32_bf16 v[40:43], v[104:107], v[48:51], v[40:43]
    v_mfma_f32_16x16x32_bf16 v[44:47], v[108:111], v[48:51], v[44:47]
    s_waitcnt vmcnt(3)
    buffer_load_dwordx4 v[128:131], v3, s[32:35], s49 offen offset:128 nt
    s_waitcnt vmcnt(3)
    buffer_load_dwordx4 v[132:135], v3, s[32:35], s49 offen offset:256 nt
    s_waitcnt vmcnt(1)
    s_add_u32 s49, s48, 1572864
    s_sub_u32 s95, s49, 3145728
    s_min_u32 s49, s49, s95
    buffer_load_dwordx4 v[88:91], v3, s[32:35], s49 offen offset:0 nt
    v_and_b32 v48, v26, v4
    v_and_b32 v49, v26, v5
    v_and_b32 v50, v26, v6
    v_and_b32 v51, v26, v7
    s_nop 1
    v_mfma_f32_16x16x32_bf16 v[36:39], v[112:115], v[48:51], v[36:39]
    v_mfma_f32_16x16x32_bf16 v[40:43], v[116:119], v[48:51], v[40:43]
    v_mfma_f32_16x16x32_bf16 v[44:47], v[120:123], v[48:51], v[44:47]
    s_waitcnt vmcnt(3)
    buffer_load_dwordx4 v[92:95], v3, s[32:35], s49 offen offset:128 nt
    s_waitcnt vmcnt(3)
    buffer_load_dwordx4 v[96:99], v3, s[32:35], s49 offen offset:256 nt
    s_waitcnt vmcnt(1)
    s_add_u32 s49, s48, 1769472
    s_sub_u32 s95, s49, 3145728
    s_min_u32 s49, s49, s95
    buffer_load_dwordx4 v[76:79], v3, s[32:35], s49 offen offset:0 nt
    v_and_b32 v48, v27, v4
    v_and_b32 v49, v27, v5
    v_and_b32 v50, v27, v6
    v_and_b32 v51, v27, v7
    s_nop 1
    v_mfma_f32_16x16x32_bf16 v[36:39], v[124:127], v[48:51], v[36:39]
    v_mfma_f32_16x16x32_bf16 v[40:43], v[128:131], v[48:51], v[40:43]
    v_mfma_f32_16x16x32_bf16 v[44:47], v[132:135], v[48:51], v[44:47]
    s_waitcnt vmcnt(2)
    buffer_load_dwordx4 v[80:83], v3, s[32:35], s49 offen offset:128 nt
    s_waitcnt vmcnt(2)
    buffer_load_dwordx4 v[84:87], v3, s[32:35], s49 offen offset:256 nt
    v_and_b32 v48, v28, v4
    v_and_b32 v49, v28, v5
    v_and_b32 v50, v28, v6
    v_and_b32 v51, v28, v7
    s_nop 1
    v_mfma_f32_16x16x32_bf16 v[36:39], v[88:91], v[48:51], v[36:39]
    v_mfma_f32_16x16x32_bf16 v[40:43], v[92:95], v[48:51], v[40:43]
    v_mfma_f32_16x16x32_bf16 v[44:47], v[96:99], v[48:51], v[44:47]
    s_cmp_lg_u32 s3, 0
    s_cbranch_scc1 L_ntk22
    s_mov_b32 s88, 8
    s_atomic_add s88, s[86:87], 0 glc
L_ntk22:
    v_mov_b32 v20, v29
    s_branch L_enter
L_enter_wo:
    v_and_b32 v30, 3, v1
    v_mul_u32_u24 v30, 0x5555, v30
    v_mov_b32 v136, 0xffff
    v_mov_b32 v137, 0
    v_mov_b32 v138, 0xffff0000
    v_mov_b32 v139, 0
    s_mov_b32 exec_lo, 0xf0f0f0f0
    s_mov_b32 exec_hi, 0xf0f0f0f0
    v_mov_b32 v136, 0
    v_mov_b32 v137, 0xffff
    v_mov_b32 v138, 0
    v_mov_b32 v139, 0xffff0000
    s_mov_b64 exec, -1
    s_lshr_b32 s80, s3, 1
    s_lshl_b32 s81, s55, 2
    s_add_u32 s80, s80, s81
    s_lshl_b32 s80, s80, 13
    s_add_u32 s80, s80, 262144
    s_and_b32 s81, s3, 1
    s_lshl_b32 s81, s81, 9
    s_add_u32 s59, s81, s80
    v_and_b32 v60, 3, v1
    v_lshl_add_u32 v60, v56, 2, v60
    v_lshlrev_b32 v60, 4, v60
    v_bfe_u32 v62, v1, 2, 1
    v_lshl_add_u32 v140, v62, 12, v60
    v_and_b32 v60, 1, v56
    v_lshlrev_b32 v60, 3, v60
    v_lshrrev_b32 v62, 1, v56
    s_lshl_b32 s95, s3, 2
    v_add3_u32 v60, v60, v62, s95
    v_mul_u32_u24 v62, 1568, v57
    v_lshl_add_u32 v141, v60, 4, v62
    s_lshl_b32 s95, s3, 7
    s_mul_i32 s54, s55, 2560
    s_add_u32 s54, s54, s95
    s_lshr_b32 s95, s55, 1
    s_mul_i32 s95, s95, 11264
    s_add_u32 s54, s54, s95
    s_lshl_b32 s95, s50, 8
    s_add_u32 s54, s54, s95
    s_add_u32 s54, s54, 1581056
    v_lshlrev_b32 v33, 4, v56
    v_mov_b32 v144, 0
    v_mov_b32 v145, 0
    v_mov_b32 v146, 0
    v_mov_b32 v147, 0
L_enter:
    s_mov_b32 s58, 0
    s_lshl_b32 s80, s3, 3
    v_mov_b32 v29, s80
    v_lshlrev_b32 v28, 3, v57
    v_add_u32 v60, s80, v56
    v_and_b32 v62, 3, v60
    v_lshrrev_b32 v61, 5, v60
    v_bfe_u32 v60, v60, 2, 3
    v_lshl_add_u32 v60, v62, 3, v60
    v_mad_u32_u24 v60, v61, 24, v60
    v_mul_u32_u24 v61, 1568, v57
    v_lshl_add_u32 v22, v60, 4, v61
    s_lshl_b32 s80, s3, 7
    s_lshl_b32 s81, s83, 10
    s_add_u32 s80, s80, s81
    s_lshl_b32 s81, s82, 13
    s_add_u32 s81, s81, 262144
    s_add_u32 s56, s80, s81
    v_lshlrev_b32 v23, 4, v56
    s_xor_b32 s58, s58, 4
    v_mov_b32 v61, s58
    s_cmp_lg_u32 s3, 0
    s_cbranch_scc1 L_tg23
    s_waitcnt lgkmcnt(0)
    v_mov_b32 v62, s88
    ds_write_b32 v61, v62 offset:16
    s_waitcnt lgkmcnt(0)
L_tg23:
    s_barrier
    ds_read_b32 v62, v61 offset:16
    s_waitcnt lgkmcnt(0)
    v_readfirstlane_b32 s80, v62
    s_nop 0
    s_add_u32 s52, s100, s80
    s_andn2_b32 s52, s52, 7
    s_add_u32 s52, s52, s3
    s_cmp_lt_u32 s52, 1024
    s_cbranch_scc0 L_last
    s_sub_u32 s80, s52, s100
    s_add_u32 s80, s80, 1
    s_lshr_b32 s80, s80, 3
    s_mul_i32 s80, s80, 7
    s_cmp_lt_u32 s80, 63
    s_cselect_b64 s[62:63], s[60:61], s[76:77]
    s_cselect_b32 s95, 0, 63
    s_sub_u32 s80, s80, s95
    s_lshr_b64 s[62:63], s[62:63], s80
    s_and_b32 s62, s62, 127
    s_lshl3_add_u32 s62, s62, s3
    s_cmp_lt_u32 s52, 960
    s_cselect_b32 s62, s62, s52
    s_mul_i32 s49, s62, 3072
    s_add_u32 s49, s49, s15
    s_sub_u32 s95, s49, 3145728
    s_min_u32 s49, s49, s95
    buffer_load_dwordx4 v[64:67], v2, s[28:31], s49 offen offset:0 nt
    s_cmp_ge_u32 s52, 1008
    s_cbranch_scc1 L_bo24
    s_waitcnt vmcnt(3)
L_bo24:
    buffer_load_dwordx4 v[68:71], v2, s[28:31], s49 offen offset:128 nt
    s_cmp_ge_u32 s52, 1008
    s_cbranch_scc1 L_bo25
    s_waitcnt vmcnt(3)
L_bo25:
    buffer_load_dwordx4 v[72:75], v2, s[28:31], s49 offen offset:256 nt
    s_branch L_after_sm
L_rescale:
    v_mov_b32 v60, v20
    s_nop 1
    v_max_f32_dpp v60, v60, v60 row_ror:8 row_mask:0xf bank_mask:0xf
    s_nop 1
    v_max_f32_dpp v60, v60, v60 row_bcast:15 row_mask:0xa bank_mask:0xf
    s_nop 1
    v_max_f32_dpp v60, v60, v60 row_bcast:31 row_mask:0xc bank_mask:0xf
    s_nop 0
    v_readlane_b32 s80, v60, 63
    s_nop 1
    v_sub_f32 v60, v58, s80
    v_mul_f32 v60, s85, v60
    v_exp_f32 v60, v60
    v_mov_b32 v58, s80
    v_mul_f32 v36, v36, v60
    v_mul_f32 v37, v37, v60
    v_mul_f32 v38, v38, v60
    v_mul_f32 v39, v39, v60
    v_mul_f32 v40, v40, v60
    v_mul_f32 v41, v41, v60
    v_mul_f32 v42, v42, v60
    v_mul_f32 v43, v43, v60
    v_mul_f32 v44, v44, v60
    v_mul_f32 v45, v45, v60
    v_mul_f32 v46, v46, v60
    v_mul_f32 v47, v47, v60
    v_mul_f32 v59, v59, v60
    s_branch L_back
.p2align 6
L_top:
    s_xor_b32 s58, s58, 4
    v_mov_b32 v61, s58
    s_cmp_lg_u32 s3, 0
    s_cbranch_scc1 L_tg26
    s_waitcnt lgkmcnt(0)
    v_mov_b32 v62, s88
    ds_write_b32 v61, v62 offset:16
    s_waitcnt lgkmcnt(0)
L_tg26:
    s_barrier
    ds_read_b32 v62, v61 offset:16
    s_waitcnt lgkmcnt(0)
    v_readfirstlane_b32 s80, v62
    s_nop 0
    s_add_u32 s52, s100, s80
    s_andn2_b32 s52, s52, 7
    s_add_u32 s52, s52, s3
    s_sub_u32 s80, s52, s100
    s_add_u32 s80, s80, 1
    s_lshr_b32 s80, s80, 3
    s_mul_i32 s80, s80, 7
    s_cmp_lt_u32 s80, 63
    s_cselect_b64 s[62:63], s[60:61], s[76:77]
    s_cselect_b32 s95, 0, 63
    s_sub_u32 s80, s80, s95
    s_lshr_b64 s[62:63], s[62:63], s80
    s_and_b32 s62, s62, 127
    s_lshl3_add_u32 s62, s62, s3
    s_cmp_lt_u32 s52, 960
    s_cselect_b32 s62, s62, s52
    s_mul_i32 s49, s62, 3072
    s_add_u32 s49, s49, s15
    s_sub_u32 s95, s49, 3145728
    s_min_u32 s49, s49, s95
    s_waitcnt vmcnt(3)
    v_mfma_f32_16x16x32_bf16 v[52:55], v[64:67], v[8:11], 0
    v_mfma_f32_16x16x32_bf16 v[52:55], v[68:71], v[12:15], v[52:55]
    v_mfma_f32_16x16x32_bf16 v[52:55], v[72:75], v[16:19], v[52:55]
    s_cmp_lt_u32 s52, 1024
    s_cbranch_scc0 L_skipk
    buffer_load_dwordx4 v[64:67], v2, s[28:31], s49 offen offset:0 nt
    s_cmp_ge_u32 s52, 1008
    s_cbranch_scc1 L_bo27
    s_waitcnt vmcnt(3)
L_bo27:
    buffer_load_dwordx4 v[68:71], v2, s[28:31], s49 offen offset:128 nt
    s_cmp_ge_u32 s52, 1008
    s_cbranch_scc1 L_bo28
    s_waitcnt vmcnt(3)
L_bo28:
    buffer_load_dwordx4 v[72:75], v2, s[28:31], s49 offen offset:256 nt
L_skipk:
    s_nop 5
    v_mov_b32_dpp v20, v52 quad_perm:[0,0,0,0] row_mask:0xf bank_mask:0xf
    v_add_f32_dpp v20, v53, v20 quad_perm:[1,1,1,1] row_mask:0xf bank_mask:0xf
    v_add_f32_dpp v20, v54, v20 quad_perm:[2,2,2,2] row_mask:0xf bank_mask:0xf
    v_add_f32_dpp v20, v55, v20 quad_perm:[3,3,3,3] row_mask:0xf bank_mask:0xf
    v_cvt_pk_bf16_f32 v20, v20, v20
    v_and_b32 v20, 0xffff0000, v20
    v_mul_f32 v20, s84, v20
    v_cvt_pk_bf16_f32 v20, v20, v20
    v_and_b32 v20, 0xffff0000, v20
    v_cmp_gt_f32 vcc, v20, v58
    s_nop 1
    s_cbranch_vccnz L_rescale
L_back:
    v_sub_f32 v20, v20, v58
    v_mul_f32 v20, s85, v20
    v_exp_f32 v20, v20
    s_nop 0
    v_add_f32 v59, v59, v20
    s_cmp_lt_u32 s52, 1024
    s_cbranch_scc0 L_last
L_after_sm:
    s_cmp_lg_u32 s3, 0
    s_cbranch_scc1 L_nw29
    s_load_dword s74, s[86:87], 0 glc
L_nw29:
    v_cvt_pk_bf16_f32 v20, v20, v20
    v_and_b32 v48, v20, v4
    v_and_b32 v49, v20, v5
    v_and_b32 v50, v20, v6
    v_and_b32 v51, v20, v7
    s_waitcnt vmcnt(3)
    s_nop 0
    v_mfma_f32_16x16x32_bf16 v[36:39], v[76:79], v[48:51], v[36:39]
    v_mfma_f32_16x16x32_bf16 v[40:43], v[80:83], v[48:51], v[40:43]
    v_mfma_f32_16x16x32_bf16 v[44:47], v[84:87], v[48:51], v[44:47]
    buffer_load_dwordx4 v[76:79], v3, s[32:35], s49 offen offset:0 nt
    s_cmp_ge_u32 s52, 1008
    s_cbranch_scc1 L_bo30
    s_waitcnt vmcnt(3)
L_bo30:
    buffer_load_dwordx4 v[80:83], v3, s[32:35], s49 offen offset:128 nt
    s_cmp_ge_u32 s52, 1008
    s_cbranch_scc1 L_bo31
    s_waitcnt vmcnt(3)
L_bo31:
    buffer_load_dwordx4 v[84:87], v3, s[32:35], s49 offen offset:256 nt
    s_mov_b32 s88, 1024
    s_cmp_lt_u32 s52, s51
    s_cbranch_scc0 L_nt32
    s_cmp_lg_u32 s3, 0
    s_cbranch_scc1 L_ntk33
    s_waitcnt lgkmcnt(0)
    s_add_u32 s80, s74, s100
    s_mov_b32 s88, s74
    s_cmp_ge_u32 s80, 1024
    s_cbranch_scc1 L_ntk33
    s_mov_b32 s88, 8
    s_atomic_add s88, s[86:87], 0 glc
L_ntk33:
L_nt32:
    s_branch L_top
L_last:
    s_cmp_lg_u32 s89, 1
    s_cbranch_scc1 L_nolate
    s_mov_b32 s80, 0
    buffer_load_dwordx4 v[208:211], v35, s[40:43], s80 offen nt
    s_mov_b32 s80, 5120
    buffer_load_dwordx4 v[212:215], v35, s[40:43], s80 offen nt
    s_mov_b32 s80, 20480
    buffer_load_dwordx4 v[216:219], v35, s[40:43], s80 offen nt
    s_mov_b32 s80, 25600
    buffer_load_dwordx4 v[220:223], v35, s[40:43], s80 offen nt
L_nolate:
    s_cmp_lg_u32 s89, 2
    s_cbranch_scc1 L_nodl
    s_cmp_ge_u32 s3, 4
    s_cbranch_scc1 L_nodl
    s_mul_i32 s80, s50, 81920
    s_lshl_b32 s81, s3, 8
    s_add_u32 s80, s80, s81
    s_add_u32 s72, s20, s80
    s_addc_u32 s73, s21, 0
    s_sub_u32 s74, 1966080, s80
    s_mov_b32 s75, 0x20000
    v_lshrrev_b32 v35, 2, v56
    v_mul_u32_u24 v35, 40960, v35
    v_and_b32 v60, 1, v56
    v_mul_u32_u24 v60, 20480, v60
    v_bfe_u32 v61, v56, 1, 1
    v_mul_u32_u24 v61, 1280, v61
    v_add3_u32 v35, v35, v60, v61
    v_lshl_add_u32 v35, v57, 4, v35
    s_mov_b32 s80, 10240
    buffer_load_dwordx4 v[128:131], v35, s[72:75], s80 offen offset:0 nt
    s_mov_b32 s80, 15360
    buffer_load_dwordx4 v[132:135], v35, s[72:75], s80 offen offset:0 nt
    s_mov_b32 s80, 12800
    buffer_load_dwordx4 v[136:139], v35, s[72:75], s80 offen offset:0 nt
    s_mov_b32 s80, 17920
    buffer_load_dwordx4 v[140:143], v35, s[72:75], s80 offen offset:0 nt
    s_mov_b32 s80, 0
    buffer_load_dwordx4 v[144:147], v35, s[72:75], s80 offen offset:128 nt
    s_mov_b32 s80, 5120
    buffer_load_dwordx4 v[148:151], v35, s[72:75], s80 offen offset:128 nt
    s_mov_b32 s80, 2560
    buffer_load_dwordx4 v[152:155], v35, s[72:75], s80 offen offset:128 nt
    s_mov_b32 s80, 7680
    buffer_load_dwordx4 v[156:159], v35, s[72:75], s80 offen offset:128 nt
L_nodl:
    v_add_f32_dpp v59, v59, v59 row_ror:8 row_mask:0xf bank_mask:0xf
    s_nop 1
    v_add_f32_dpp v59, v59, v59 row_bcast:15 row_mask:0xa bank_mask:0xf
    s_nop 1
    v_add_f32_dpp v59, v59, v59 row_bcast:31 row_mask:0xc bank_mask:0xf
    s_mov_b32 exec_lo, 0
    s_mov_b32 exec_hi, 0x80000000
    ds_write_b64 v29, v[58:59] offset:448
    s_mov_b64 exec, -1
    s_waitcnt lgkmcnt(0)
    s_barrier
    ds_read_b64 v[24:25], v28 offset:448
    s_waitcnt lgkmcnt(0)
    v_max_f32_dpp v26, v24, v24 quad_perm:[1,0,3,2] row_mask:0xf bank_mask:0xf
    s_nop 1
    v_max_f32_dpp v26, v26, v26 quad_perm:[2,3,0,1] row_mask:0xf bank_mask:0xf
    s_nop 1
    v_max_f32_dpp v26, v26, v26 row_half_mirror row_mask:0xf bank_mask:0xf
    v_sub_f32 v21, v58, v26
    v_sub_f32 v24, v24, v26
    v_mul_f32 v21, s85, v21
    v_mul_f32 v24, s85, v24
    v_exp_f32 v21, v21
    v_exp_f32 v24, v24
    v_mul_f32 v20, v20, v21
    v_mul_f32 v27, v24, v25
    v_mul_f32 v26, s85, v26
    v_cvt_pk_bf16_f32 v20, v20, v20
    v_and_b32 v48, v20, v4
    v_and_b32 v49, v20, v5
    v_and_b32 v50, v20, v6
    v_and_b32 v51, v20, v7
    v_mul_f32 v36, v36, v21
    v_add_f32_dpp v27, v27, v27 quad_perm:[1,0,3,2] row_mask:0xf bank_mask:0xf
    v_mul_f32 v37, v37, v21
    v_mul_f32 v38, v38, v21
    v_mul_f32 v39, v39, v21
    v_mul_f32 v40, v40, v21
    v_add_f32_dpp v27, v27, v27 quad_perm:[2,3,0,1] row_mask:0xf bank_mask:0xf
    v_mul_f32 v41, v41, v21
    v_mul_f32 v42, v42, v21
    v_mul_f32 v43, v43, v21
    v_mul_f32 v44, v44, v21
    v_add_f32_dpp v27, v27, v27 row_half_mirror row_mask:0xf bank_mask:0xf
    v_mul_f32 v45, v45, v21
    v_mul_f32 v46, v46, v21
    v_mul_f32 v47, v47, v21
    s_cmp_lg_u32 s89, 2
    s_cbranch_scc1 L_lw0
    s_cmp_lt_u32 s3, 4
    s_cbranch_scc1 L_lw2
L_lw0:
    s_cmp_eq_u32 s89, 1
    s_cbranch_scc1 L_lw
    s_waitcnt vmcnt(0)
L_lw:
    s_waitcnt vmcnt(4)
L_lw2:
    s_waitcnt vmcnt(8)
    v_mfma_f32_16x16x32_bf16 v[36:39], v[76:79], v[48:51], v[36:39]
    v_mfma_f32_16x16x32_bf16 v[40:43], v[80:83], v[48:51], v[40:43]
    v_mfma_f32_16x16x32_bf16 v[44:47], v[84:87], v[48:51], v[44:47]
    s_mov_b64 exec, s[90:91]
    s_nop 4
    ds_write_b128 v63, v[36:39] offset:3200
    ds_write_b128 v63, v[40:43] offset:3456
    ds_write_b128 v63, v[44:47] offset:3712
    s_mov_b64 exec, -1
    s_waitcnt lgkmcnt(0)
    s_barrier
    ds_read_b128 v[48:51], v22 offset:3200
    ds_read_b128 v[52:55], v22 offset:3968
    s_waitcnt lgkmcnt(0)
    v_pk_add_f32 v[48:49], v[48:49], v[52:53]
    v_pk_add_f32 v[50:51], v[50:51], v[54:55]
    s_nop 0
    v_add_f32_dpp v48, v48, v48 quad_perm:[1,0,3,2] row_mask:0xf bank_mask:0xf
    v_add_f32_dpp v49, v49, v49 quad_perm:[1,0,3,2] row_mask:0xf bank_mask:0xf
    v_add_f32_dpp v50, v50, v50 quad_perm:[1,0,3,2] row_mask:0xf bank_mask:0xf
    v_add_f32_dpp v51, v51, v51 quad_perm:[1,0,3,2] row_mask:0xf bank_mask:0xf
    v_add_f32_dpp v48, v48, v48 quad_perm:[2,3,0,1] row_mask:0xf bank_mask:0xf
    v_add_f32_dpp v49, v49, v49 quad_perm:[2,3,0,1] row_mask:0xf bank_mask:0xf
    v_add_f32_dpp v50, v50, v50 quad_perm:[2,3,0,1] row_mask:0xf bank_mask:0xf
    v_add_f32_dpp v51, v51, v51 quad_perm:[2,3,0,1] row_mask:0xf bank_mask:0xf
    v_add_f32_dpp v48, v48, v48 row_half_mirror row_mask:0xf bank_mask:0xf
    v_add_f32_dpp v49, v49, v49 row_half_mirror row_mask:0xf bank_mask:0xf
    v_add_f32_dpp v50, v50, v50 row_half_mirror row_mask:0xf bank_mask:0xf
    v_add_f32_dpp v51, v51, v51 row_half_mirror row_mask:0xf bank_mask:0xf
    s_mov_b32 exec_lo, 0x01000000
    s_mov_b32 exec_hi, 0x01000000
    v_pk_mov_b32 v[48:49], v[26:27], v[26:27] op_sel:[0,1]
    v_pk_mov_b32 v[50:51], v[26:27], v[26:27] op_sel:[0,1]
    s_mov_b32 exec_lo, 0x01010101
    s_mov_b32 exec_hi, 0x01010101
    buffer_store_dwordx4 v[48:51], v23, s[36:39], s56 offen sc1
    s_mov_b64 exec, -1
    s_cmp_eq_u32 s89, 0
    s_cbranch_scc1 L_done
    s_cmp_eq_u32 s89, 2
    s_cbranch_scc1 L_role_ffn
    s_waitcnt vmcnt(0)
    s_mov_b32 s94, 1048576
L_poll34:
    buffer_load_dwordx4 v[64:67], v140, s[36:39], s59 offen offset:0 sc1
    buffer_load_dwordx4 v[68:71], v140, s[36:39], s59 offen offset:1024 sc1
    buffer_load_dwordx4 v[72:75], v140, s[36:39], s59 offen offset:2048 sc1
    buffer_load_dwordx4 v[76:79], v140, s[36:39], s59 offen offset:3072 sc1
    s_waitcnt vmcnt(0)
    v_max3_u32 v62, v64, v68, v72
    v_max_u32 v62, v62, v76
    v_cmp_eq_u32 vcc, -1, v62
    s_nop 1
    s_cbranch_vccz L_pok34
    s_sub_u32 s94, s94, 1
    s_cmp_lg_u32 s94, 0
    s_cbranch_scc1 L_poll34
L_pok34:
    v_max3_f32 v62, v64, v68, v72
    v_max_f32 v62, v62, v76
    s_nop 1
    v_max_f32_dpp v61, v62, v62 row_shl:4 row_mask:0xf bank_mask:0x5
    v_max_f32_dpp v61, v62, v62 row_shr:4 row_mask:0xf bank_mask:0xa
    s_nop 1
    v_mov_b32_dpp v61, v61 quad_perm:[3,3,3,3] row_mask:0xf bank_mask:0xf
    v_sub_f32_dpp v8, v64, v61 quad_perm:[3,3,3,3] row_mask:0xf bank_mask:0xf
    v_sub_f32_dpp v10, v68, v61 quad_perm:[3,3,3,3] row_mask:0xf bank_mask:0xf
    v_sub_f32_dpp v12, v72, v61 quad_perm:[3,3,3,3] row_mask:0xf bank_mask:0xf
    v_sub_f32_dpp v14, v76, v61 quad_perm:[3,3,3,3] row_mask:0xf bank_mask:0xf
    v_exp_f32 v8, v8
    v_exp_f32 v10, v10
    v_exp_f32 v12, v12
    v_exp_f32 v14, v14
    v_pk_mul_f32 v[20:21], v[8:9], v[64:65] op_sel_hi:[0,1]
    v_pk_mul_f32 v[22:23], v[8:9], v[66:67] op_sel_hi:[0,1]
    v_pk_fma_f32 v[20:21], v[10:11], v[68:69], v[20:21] op_sel_hi:[0,1,1]
    v_pk_fma_f32 v[22:23], v[10:11], v[70:71], v[22:23] op_sel_hi:[0,1,1]
    v_pk_fma_f32 v[20:21], v[12:13], v[72:73], v[20:21] op_sel_hi:[0,1,1]
    v_pk_fma_f32 v[22:23], v[12:13], v[74:75], v[22:23] op_sel_hi:[0,1,1]
    v_pk_fma_f32 v[20:21], v[14:15], v[76:77], v[20:21] op_sel_hi:[0,1,1]
    v_pk_fma_f32 v[22:23], v[14:15], v[78:79], v[22:23] op_sel_hi:[0,1,1]
    v_cmp_u_f32 vcc, v20, v21
    v_cmp_u_f32 s[4:5], v22, v23
    v_add_f32_dpp v25, v21, v21 row_shl:4 row_mask:0xf bank_mask:0x5
    v_add_f32_dpp v25, v21, v21 row_shr:4 row_mask:0xf bank_mask:0xa
    v_add_f32_dpp v24, v20, v20 row_shl:4 row_mask:0xf bank_mask:0x5
    v_add_f32_dpp v24, v20, v20 row_shr:4 row_mask:0xf bank_mask:0xa
    v_rcp_f32_dpp v28, v25 quad_perm:[3,3,3,3] row_mask:0xf bank_mask:0xf
    v_add_f32_dpp v26, v22, v22 row_shl:4 row_mask:0xf bank_mask:0x5
    v_add_f32_dpp v26, v22, v22 row_shr:4 row_mask:0xf bank_mask:0xa
    v_add_f32_dpp v27, v23, v23 row_shl:4 row_mask:0xf bank_mask:0x5
    v_add_f32_dpp v27, v23, v23 row_shr:4 row_mask:0xf bank_mask:0xa
    v_pk_mul_f32 v[24:25], v[28:29], v[24:25] op_sel_hi:[0,1]
    v_pk_mul_f32 v[26:27], v[28:29], v[26:27] op_sel_hi:[0,1]
    v_cvt_pk_bf16_f32 v20, v24, v25
    v_cvt_pk_bf16_f32 v21, v26, v27
    s_or_b64 vcc, vcc, s[4:5]
    s_cbranch_scc1 L_rc34
L_rb34:
    v_and_b32_dpp v48, v20, v136 quad_perm:[0,0,0,0] row_mask:0xf bank_mask:0xf
    v_and_b32_dpp v49, v20, v137 quad_perm:[0,0,0,0] row_mask:0xf bank_mask:0xf
    v_and_b32_dpp v50, v20, v138 quad_perm:[0,0,0,0] row_mask:0xf bank_mask:0xf
    v_and_b32_dpp v51, v20, v139 quad_perm:[0,0,0,0] row_mask:0xf bank_mask:0xf
    v_and_b32_dpp v52, v21, v136 quad_perm:[0,0,0,0] row_mask:0xf bank_mask:0xf
    v_and_b32_dpp v53, v21, v137 quad_perm:[0,0,0,0] row_mask:0xf bank_mask:0xf
    v_and_b32_dpp v54, v21, v138 quad_perm:[0,0,0,0] row_mask:0xf bank_mask:0xf
    v_and_b32_dpp v55, v21, v139 quad_perm:[0,0,0,0] row_mask:0xf bank_mask:0xf
    v_smfmac_f32_16x16x64_bf16 v[144:147], v[48:51], v[208:215], v30
    v_and_b32_dpp v48, v20, v136 quad_perm:[1,1,1,1] row_mask:0xf bank_mask:0xf
    v_and_b32_dpp v49, v20, v137 quad_perm:[1,1,1,1] row_mask:0xf bank_mask:0xf
    v_and_b32_dpp v50, v20, v138 quad_perm:[1,1,1,1] row_mask:0xf bank_mask:0xf
    v_and_b32_dpp v51, v20, v139 quad_perm:[1,1,1,1] row_mask:0xf bank_mask:0xf
    v_smfmac_f32_16x16x64_bf16 v[144:147], v[52:55], v[216:223], v30
    v_and_b32_dpp v52, v21, v136 quad_perm:[1,1,1,1] row_mask:0xf bank_mask:0xf
    v_and_b32_dpp v53, v21, v137 quad_perm:[1,1,1,1] row_mask:0xf bank_mask:0xf
    v_and_b32_dpp v54, v21, v138 quad_perm:[1,1,1,1] row_mask:0xf bank_mask:0xf
    v_and_b32_dpp v55, v21, v139 quad_perm:[1,1,1,1] row_mask:0xf bank_mask:0xf
    v_smfmac_f32_16x16x64_bf16 v[144:147], v[48:51], v[224:231], v30
    v_and_b32_dpp v48, v20, v136 quad_perm:[2,2,2,2] row_mask:0xf bank_mask:0xf
    v_and_b32_dpp v49, v20, v137 quad_perm:[2,2,2,2] row_mask:0xf bank_mask:0xf
    v_and_b32_dpp v50, v20, v138 quad_perm:[2,2,2,2] row_mask:0xf bank_mask:0xf
    v_and_b32_dpp v51, v20, v139 quad_perm:[2,2,2,2] row_mask:0xf bank_mask:0xf
    v_smfmac_f32_16x16x64_bf16 v[144:147], v[52:55], v[232:239], v30
    v_and_b32_dpp v52, v21, v136 quad_perm:[2,2,2,2] row_mask:0xf bank_mask:0xf
    v_and_b32_dpp v53, v21, v137 quad_perm:[2,2,2,2] row_mask:0xf bank_mask:0xf
    v_and_b32_dpp v54, v21, v138 quad_perm:[2,2,2,2] row_mask:0xf bank_mask:0xf
    v_and_b32_dpp v55, v21, v139 quad_perm:[2,2,2,2] row_mask:0xf bank_mask:0xf
    v_smfmac_f32_16x16x64_bf16 v[144:147], v[48:51], v[240:247], v30
    s_nop 0
    v_smfmac_f32_16x16x64_bf16 v[144:147], v[52:55], v[248:255], v30
    s_mov_b64 exec, s[90:91]
    s_nop 6
    ds_write_b128 v63, v[144:147] offset:16000
    s_mov_b64 exec, -1
    s_cmp_ge_u32 s3, 2
    s_waitcnt lgkmcnt(0)
    s_barrier
    s_cbranch_scc1 L_done
    ds_read_b128 v[48:51], v141 offset:16000
    ds_read_b128 v[52:55], v141 offset:16768
    s_waitcnt lgkmcnt(0)
    v_pk_add_f32 v[48:49], v[48:49], v[52:53]
    v_pk_add_f32 v[50:51], v[50:51], v[54:55]
    s_nop 0
    v_add_f32_dpp v48, v48, v48 quad_perm:[1,0,3,2] row_mask:0xf bank_mask:0xf
    v_add_f32_dpp v49, v49, v49 quad_perm:[1,0,3,2] row_mask:0xf bank_mask:0xf
    v_add_f32_dpp v50, v50, v50 quad_perm:[1,0,3,2] row_mask:0xf bank_mask:0xf
    v_add_f32_dpp v51, v51, v51 quad_perm:[1,0,3,2] row_mask:0xf bank_mask:0xf
    v_add_f32_dpp v48, v48, v48 quad_perm:[2,3,0,1] row_mask:0xf bank_mask:0xf
    v_add_f32_dpp v49, v49, v49 quad_perm:[2,3,0,1] row_mask:0xf bank_mask:0xf
    v_add_f32_dpp v50, v50, v50 quad_perm:[2,3,0,1] row_mask:0xf bank_mask:0xf
    v_add_f32_dpp v51, v51, v51 quad_perm:[2,3,0,1] row_mask:0xf bank_mask:0xf
    v_add_f32_dpp v48, v48, v48 row_half_mirror row_mask:0xf bank_mask:0xf
    v_add_f32_dpp v49, v49, v49 row_half_mirror row_mask:0xf bank_mask:0xf
    v_add_f32_dpp v50, v50, v50 row_half_mirror row_mask:0xf bank_mask:0xf
    v_add_f32_dpp v51, v51, v51 row_half_mirror row_mask:0xf bank_mask:0xf
    s_mov_b32 exec_lo, 0x01010101
    s_mov_b32 exec_hi, 0x01010101
    buffer_store_dwordx4 v[48:51], v33, s[36:39], s54 offen sc1
    s_mov_b64 exec, -1
    s_branch L_done
L_role_ffn:
    s_cmp_lt_u32 s3, 3
    s_cbranch_scc1 L_nox
    v_and_b32 v60, 31, v1
    v_lshlrev_b32 v60, 3, v60
    v_lshrrev_b32 v61, 5, v1
    v_lshl_add_u32 v60, v61, 2, v60
    s_sub_u32 s81, s3, 3
    s_lshl_b32 s81, s81, 8
    v_add_u32 v2, s81, v60
    v_mov_b32 v22, 0
    v_mov_b32 v23, 0
    buffer_load_short_d16_hi v22, v2, s[64:67], 0 offen
    buffer_load_short_d16_hi v23, v2, s[64:67], 0 offen offset:2
    s_cmp_ge_u32 s3, 4
    s_cbranch_scc1 L_nodn
L_nox:
    s_mul_i32 s80, s50, 81920
    s_lshl_b32 s81, s3, 8
    s_add_u32 s80, s80, s81
    s_add_u32 s72, s20, s80
    s_addc_u32 s73, s21, 0
    s_sub_u32 s74, 1966080, s80
    s_mov_b32 s75, 0x20000
    v_lshrrev_b32 v35, 2, v56
    v_mul_u32_u24 v35, 40960, v35
    v_and_b32 v60, 1, v56
    v_mul_u32_u24 v60, 20480, v60
    v_bfe_u32 v61, v56, 1, 1
    v_mul_u32_u24 v61, 1280, v61
    v_add3_u32 v35, v35, v60, v61
    v_lshl_add_u32 v35, v57, 4, v35
    v_and_b32 v60, 31, v1
    v_or_b32 v61, 1, v60
    v_and_b32 v62, 3, v1
    v_cmp_eq_u32 vcc, 0, v62
    s_nop 1
    v_cndmask_b32 v60, v60, v61, vcc
    v_lshlrev_b32 v60, 3, v60
    buffer_load_dword v34, v60, s[68:71], 0 offen offset:4 sc1
    s_mov_b32 s80, 0
    buffer_load_dwordx4 v[112:115], v35, s[72:75], s80 offen offset:0 nt
    s_mov_b32 s80, 5120
    buffer_load_dwordx4 v[116:119], v35, s[72:75], s80 offen offset:0 nt
    s_mov_b32 s80, 2560
    buffer_load_dwordx4 v[120:123], v35, s[72:75], s80 offen offset:0 nt
    s_mov_b32 s80, 7680
    buffer_load_dwordx4 v[124:127], v35, s[72:75], s80 offen offset:0 nt
    v_mov_b32 v44, 0
    v_mov_b32 v45, 0
    v_mov_b32 v46, 0
    v_mov_b32 v47, 0
    v_mov_b32 v16, 0
    v_mov_b32 v17, 0
    v_mov_b32 v18, 0
    v_mov_b32 v19, 0
    s_cmp_ge_u32 s3, 2
    s_cbranch_scc1 L_nodn
    s_lshl_b32 s81, s3, 7
    s_sub_u32 s81, 1024, s81
    s_add_u32 s80, s81, 0
    buffer_load_dwordx4 v[80:83], v35, s[72:75], s80 offen nt
    s_add_u32 s80, s81, 5120
    buffer_load_dwordx4 v[84:87], v35, s[72:75], s80 offen nt
    s_add_u32 s80, s81, 2560
    buffer_load_dwordx4 v[88:91], v35, s[72:75], s80 offen nt
    s_add_u32 s80, s81, 7680
    buffer_load_dwordx4 v[92:95], v35, s[72:75], s80 offen nt
    s_add_u32 s80, s81, 10240
    buffer_load_dwordx4 v[96:99], v35, s[72:75], s80 offen nt
    s_add_u32 s80, s81, 15360
    buffer_load_dwordx4 v[100:103], v35, s[72:75], s80 offen nt
    s_add_u32 s80, s81, 12800
    buffer_load_dwordx4 v[104:107], v35, s[72:75], s80 offen nt
    s_add_u32 s80, s81, 17920
    buffer_load_dwordx4 v[108:111], v35, s[72:75], s80 offen nt
    v_mov_b32 v20, 0
    v_mov_b32 v21, 0
    v_mov_b32 v22, 0
    v_mov_b32 v23, 0
L_nodn:
    s_mov_b32 s76, s22
    s_mov_b32 s77, s23
    s_mov_b32 s78, 1280
    s_mov_b32 s79, 0x20000
    s_lshl_b32 s80, s50, 7
    v_mul_u32_u24 v3, 2560, v56
    v_lshl_add_u32 v3, v57, 4, v3
    s_lshr_b32 s81, s50, 1
    s_lshl_b32 s81, s81, 7
    s_and_b32 s95, s50, 1
    s_lshl_b32 s95, s95, 3
    s_add_u32 s81, s81, s95
    v_lshrrev_b32 v58, 4, v1
    v_lshl_add_u32 v27, v57, 3, v58
    v_lshl_add_u32 v27, v27, 1, s81
    s_add_u32 s60, s80, 589824
    s_add_u32 s61, s80, 610304
    s_add_u32 s62, s80, 630784
    v_and_b32 v30, 3, v1
    v_mul_u32_u24 v30, 0x5555, v30
    v_mov_b32 v4, 0xffff
    v_mov_b32 v5, 0
    v_mov_b32 v6, 0xffff0000
    v_mov_b32 v7, 0
    s_mov_b32 exec_lo, 0xf0f0f0f0
    s_mov_b32 exec_hi, 0xf0f0f0f0
    v_mov_b32 v4, 0
    v_mov_b32 v5, 0xffff
    v_mov_b32 v6, 0
    v_mov_b32 v7, 0xffff0000
    s_mov_b64 exec, -1
    v_mov_b32 v26, 0x3f803f80
    v_lshrrev_b32 v61, 4, v1
    v_lshl_add_u32 v31, v61, 3, v57
    v_lshlrev_b32 v31, 4, v31
    s_lshl_b32 s80, s3, 9
    v_add_u32 v32, s80, v31
    v_and_b32 v33, 3, v1
    v_lshlrev_b32 v33, 1, v33
    v_bfe_u32 v61, v1, 2, 1
    v_lshl_add_u32 v61, v56, 3, v61
    v_add_lshl_u32 v33, v33, v61, 2
    v_and_b32 v13, 0xff, v31
    v_lshrrev_b32 v61, 5, v1
    v_lshl_add_u32 v13, v61, 3, v13
    v_and_b32 v48, v26, v4
    v_and_b32 v49, v26, v5
    v_and_b32 v50, v26, v6
    v_and_b32 v51, v26, v7
    v_mov_b32 v36, 0
    v_mov_b32 v37, 0
    v_mov_b32 v38, 0
    v_mov_b32 v39, 0
    v_mov_b32 v40, 0
    v_mov_b32 v41, 0
    v_mov_b32 v42, 0
    v_mov_b32 v43, 0
    v_smfmac_f32_16x16x64_bf16 v[36:39], v[48:51], v[176:183], v30
    s_nop 0
    v_smfmac_f32_16x16x64_bf16 v[40:43], v[48:51], v[216:223], v30
    v_smfmac_f32_16x16x64_bf16 v[36:39], v[48:51], v[184:191], v30
    v_smfmac_f32_16x16x64_bf16 v[40:43], v[48:51], v[224:231], v30
    v_smfmac_f32_16x16x64_bf16 v[36:39], v[48:51], v[192:199], v30
    v_smfmac_f32_16x16x64_bf16 v[40:43], v[48:51], v[232:239], v30
    v_smfmac_f32_16x16x64_bf16 v[36:39], v[48:51], v[200:207], v30
    v_smfmac_f32_16x16x64_bf16 v[40:43], v[48:51], v[240:247], v30
    v_smfmac_f32_16x16x64_bf16 v[36:39], v[48:51], v[208:215], v30
    v_smfmac_f32_16x16x64_bf16 v[40:43], v[48:51], v[248:255], v30
    s_nop 7
    v_permlane32_swap_b32 v36, v40
    v_permlane32_swap_b32 v37, v41
    v_permlane32_swap_b32 v38, v42
    v_permlane32_swap_b32 v39, v43
    v_add_f32_dpp v36, v40, v36 row_ror:8 row_mask:0xf bank_mask:0xf
    v_add_f32_dpp v37, v41, v37 row_ror:8 row_mask:0xf bank_mask:0xf
    v_add_f32_dpp v38, v42, v38 row_ror:8 row_mask:0xf bank_mask:0xf
    v_add_f32_dpp v39, v43, v39 row_ror:8 row_mask:0xf bank_mask:0xf
    s_mov_b32 exec_lo, 0x00ff00ff
    s_mov_b32 exec_hi, 0x00ff00ff
    ds_write_b128 v32, v[36:39] offset:16384
    s_mov_b64 exec, -1
    s_mul_i32 s80, s3, 160
    v_mul_u32_u24 v28, 20, v56
    v_add_u32 v28, s80, v28
    v_mul_u32_u24 v29, 20, v1
    v_mov_b32 v63, 0
    s_mul_i32 s58, s50, 2560
    s_add_u32 s58, s58, 589824
    s_lshl_b32 s80, s3, 8
    s_add_u32 s59, s58, s80
    s_add_u32 s58, s59, s80
    s_waitcnt lgkmcnt(0)
    s_barrier
    v_mov_b32 v36, 0
    v_mov_b32 v37, 0
    v_mov_b32 v38, 0
    v_mov_b32 v39, 0
    v_mov_b32 v40, 0
    v_mov_b32 v41, 0
    v_mov_b32 v42, 0
    v_mov_b32 v43, 0
    v_mov_b32 v58, 0
    v_mov_b32 v59, 0
    s_cmp_ge_u32 s3, 4
    s_cbranch_scc1 L_nocs
    ds_read2st64_b32 v[64:65], v33 offset0:64 offset1:65
    ds_read2st64_b32 v[66:67], v33 offset0:66 offset1:67
    ds_read2st64_b32 v[68:69], v33 offset0:68 offset1:69
    ds_read2st64_b32 v[70:71], v33 offset0:70 offset1:71
    ds_read2st64_b32 v[72:73], v33 offset0:72 offset1:73
    ds_read2st64_b32 v[74:75], v33 offset0:74 offset1:75
    ds_read2st64_b32 v[76:77], v33 offset0:76 offset1:77
    ds_read2st64_b32 v[78:79], v33 offset0:78 offset1:79
    s_getreg_b32 s80, hwreg(HW_REG_XCC_ID)
    s_add_u32 s80, s80, 1
    s_waitcnt vmcnt(4) lgkmcnt(0)
    v_cmp_ne_u32 vcc, s80, v34
    v_pk_add_f32 v[64:65], v[64:65], v[66:67]
    v_pk_add_f32 v[68:69], v[68:69], v[70:71]
    v_pk_add_f32 v[64:65], v[64:65], v[68:69]
    v_pk_add_f32 v[72:73], v[72:73], v[74:75]
    v_pk_add_f32 v[76:77], v[76:77], v[78:79]
    v_pk_add_f32 v[72:73], v[72:73], v[76:77]
    v_pk_add_f32 v[24:25], v[64:65], v[72:73]
    s_mov_b64 s[96:97], vcc
    s_cmp_lt_u32 s3, 3
    s_cbranch_scc1 L_barA
L_nocs:
    v_lshrrev_b32 v61, 5, v1
    v_mul_u32_u24 v60, 2560, v61
    v_and_b32 v62, 31, v1
    v_lshl_add_u32 v60, v62, 4, v60
    s_sub_u32 s80, s3, 3
    s_lshl_b32 s80, s80, 9
    s_add_u32 s54, s80, 1581056
    s_add_u32 s55, s80, 1597440
    s_add_u32 s56, s80, 1613824
    s_add_u32 s57, s80, 1630208
    s_mov_b32 s94, 1048576
L_poll35:
    buffer_load_dwordx4 v[80:83], v60, s[36:39], s54 offen sc1
    buffer_load_dwordx4 v[84:87], v60, s[36:39], s55 offen sc1
    buffer_load_dwordx4 v[88:91], v60, s[36:39], s56 offen sc1
    buffer_load_dwordx4 v[92:95], v60, s[36:39], s57 offen sc1
    s_waitcnt vmcnt(0)
    v_max3_u32 v62, v80, v84, v88
    v_max_u32 v62, v62, v92
    v_cmp_eq_u32 vcc, -1, v62
    s_nop 1
    s_cbranch_vccz L_pok35
    s_sub_u32 s94, s94, 1
    s_cmp_lg_u32 s94, 0
    s_cbranch_scc1 L_poll35
L_pok35:
    v_pk_add_f32 v[8:9], v[80:81], v[84:85]
    v_pk_add_f32 v[12:13], v[88:89], v[92:93]
    v_pk_add_f32 v[10:11], v[82:83], v[86:87]
    v_pk_add_f32 v[14:15], v[90:91], v[94:95]
    v_pk_add_f32 v[8:9], v[8:9], v[12:13]
    v_pk_add_f32 v[10:11], v[10:11], v[14:15]
    s_nop 1
    v_permlane32_swap_b32 v8, v10
    v_permlane32_swap_b32 v9, v11
    v_pk_add_f32 v[8:9], v[8:9], v[10:11]
    v_cvt_pk_bf16_f32 v10, v8, v9
    v_lshlrev_b32 v8, 16, v10
    v_and_b32 v9, 0xffff0000, v10
    v_pk_add_f32 v[8:9], v[8:9], v[22:23]
    v_cvt_pk_bf16_f32 v10, v8, v9
    ds_write_b32 v2, v10 offset:576
    v_cmp_u_f32 vcc, v8, v9
    s_nop 1
    s_waitcnt lgkmcnt(0)
    s_cbranch_vccnz L_rc35
L_rb35:
L_barA:
    s_cmp_eq_u32 s3, 2
    s_barrier
    s_cbranch_scc1 L_stats
    ds_read2_b32 v[8:9], v28 offset0:144 offset1:145
    ds_read2_b32 v[10:11], v28 offset0:146 offset1:147
    ds_read_b32 v12, v28 offset:592
    s_waitcnt lgkmcnt(2)
    v_and_b32 v48, v8, v4
    v_and_b32 v49, v8, v5
    v_and_b32 v50, v8, v6
    v_and_b32 v51, v8, v7
    v_and_b32 v52, v9, v4
    v_and_b32 v53, v9, v5
    v_smfmac_f32_16x16x64_bf16 v[36:39], v[48:51], v[176:183], v30
    v_and_b32 v54, v9, v6
    v_and_b32 v55, v9, v7
    v_smfmac_f32_16x16x64_bf16 v[40:43], v[48:51], v[216:223], v30
    s_waitcnt lgkmcnt(0)
    v_smfmac_f32_16x16x64_bf16 v[36:39], v[52:55], v[184:191], v30
    v_and_b32 v48, v10, v4
    v_and_b32 v49, v10, v5
    v_and_b32 v50, v10, v6
    v_and_b32 v51, v10, v7
    v_smfmac_f32_16x16x64_bf16 v[40:43], v[52:55], v[224:231], v30
    s_nop 0
    v_smfmac_f32_16x16x64_bf16 v[36:39], v[48:51], v[192:199], v30
    v_and_b32 v52, v11, v4
    v_and_b32 v53, v11, v5
    v_and_b32 v54, v11, v6
    v_and_b32 v55, v11, v7
    v_smfmac_f32_16x16x64_bf16 v[40:43], v[48:51], v[232:239], v30
    s_nop 0
    v_smfmac_f32_16x16x64_bf16 v[36:39], v[52:55], v[200:207], v30
    v_and_b32 v48, v12, v4
    v_and_b32 v49, v12, v5
    v_and_b32 v50, v12, v6
    v_and_b32 v51, v12, v7
    v_smfmac_f32_16x16x64_bf16 v[40:43], v[52:55], v[240:247], v30
    s_nop 0
    v_smfmac_f32_16x16x64_bf16 v[36:39], v[48:51], v[208:215], v30
    v_smfmac_f32_16x16x64_bf16 v[40:43], v[48:51], v[248:255], v30
    s_branch L_gudone
L_stats:
    ds_read2_b32 v[80:81], v29 offset0:144 offset1:145
    ds_read2_b32 v[82:83], v29 offset0:146 offset1:147
    ds_read_b32 v84, v29 offset:592
    ds_read2_b32 v[8:9], v28 offset0:144 offset1:145
    ds_read2_b32 v[10:11], v28 offset0:146 offset1:147
    ds_read_b32 v12, v28 offset:592
    s_waitcnt lgkmcnt(3)
    v_dot2_f32_bf16 v59, v80, v80, v59
    v_dot2_f32_bf16 v58, v80, v26, v58
    v_dot2_f32_bf16 v59, v81, v81, v59
    v_dot2_f32_bf16 v58, v81, v26, v58
    v_dot2_f32_bf16 v59, v82, v82, v59
    v_dot2_f32_bf16 v58, v82, v26, v58
    v_dot2_f32_bf16 v59, v83, v83, v59
    v_dot2_f32_bf16 v58, v83, v26, v58
    v_dot2_f32_bf16 v59, v84, v84, v59
    v_dot2_f32_bf16 v58, v84, v26, v58
    s_waitcnt lgkmcnt(2)
    v_and_b32 v48, v8, v4
    v_and_b32 v49, v8, v5
    v_and_b32 v50, v8, v6
    v_and_b32 v51, v8, v7
    v_and_b32 v52, v9, v4
    v_and_b32 v53, v9, v5
    v_smfmac_f32_16x16x64_bf16 v[36:39], v[48:51], v[176:183], v30
    v_and_b32 v54, v9, v6
    v_and_b32 v55, v9, v7
    v_add_f32_dpp v59, v59, v59 quad_perm:[1,0,3,2] row_mask:0xf bank_mask:0xf
    v_add_f32_dpp v58, v58, v58 quad_perm:[1,0,3,2] row_mask:0xf bank_mask:0xf
    s_nop 0
    v_add_f32_dpp v59, v59, v59 quad_perm:[2,3,0,1] row_mask:0xf bank_mask:0xf
    v_smfmac_f32_16x16x64_bf16 v[40:43], v[48:51], v[216:223], v30
    v_add_f32_dpp v58, v58, v58 quad_perm:[2,3,0,1] row_mask:0xf bank_mask:0xf
    v_add_f32_dpp v59, v59, v59 row_half_mirror row_mask:0xf bank_mask:0xf
    s_nop 0
    v_add_f32_dpp v58, v58, v58 row_half_mirror row_mask:0xf bank_mask:0xf
    s_waitcnt lgkmcnt(0)
    v_smfmac_f32_16x16x64_bf16 v[36:39], v[52:55], v[184:191], v30
    v_and_b32 v48, v10, v4
    v_and_b32 v49, v10, v5
    v_and_b32 v50, v10, v6
    v_and_b32 v51, v10, v7
    v_add_f32_dpp v59, v59, v59 row_ror:8 row_mask:0xf bank_mask:0xf
    v_add_f32_dpp v58, v58, v58 row_ror:8 row_mask:0xf bank_mask:0xf
    s_nop 0
    v_add_f32_dpp v59, v59, v59 row_bcast:15 row_mask:0xa bank_mask:0xf
    v_smfmac_f32_16x16x64_bf16 v[40:43], v[52:55], v[224:231], v30
    v_add_f32_dpp v58, v58, v58 row_bcast:15 row_mask:0xa bank_mask:0xf
    v_add_f32_dpp v59, v59, v59 row_bcast:31 row_mask:0xc bank_mask:0xf
    s_nop 0
    v_add_f32_dpp v58, v58, v58 row_bcast:31 row_mask:0xc bank_mask:0xf
    v_smfmac_f32_16x16x64_bf16 v[36:39], v[48:51], v[192:199], v30
    v_and_b32 v52, v11, v4
    v_and_b32 v53, v11, v5
    v_and_b32 v54, v11, v6
    v_and_b32 v55, v11, v7
    v_mul_f32 v59, 0x3acccccd, v59
    v_mul_f32 v58, 0x3acccccd, v58
    v_fma_f32 v59, -v58, v58, v59
    v_smfmac_f32_16x16x64_bf16 v[40:43], v[48:51], v[232:239], v30
    v_max_f32 v59, 0, v59
    v_cvt_pk_bf16_f32 v59, v58, v59
    v_lshlrev_b32 v58, 16, v59
    v_smfmac_f32_16x16x64_bf16 v[36:39], v[52:55], v[200:207], v30
    v_and_b32 v48, v12, v4
    v_and_b32 v49, v12, v5
    v_and_b32 v50, v12, v6
    v_and_b32 v51, v12, v7
    v_and_b32 v59, 0xffff0000, v59
    v_add_f32 v59, 0x3727c5ac, v59
    v_cvt_pk_bf16_f32 v59, v59, v59
    v_smfmac_f32_16x16x64_bf16 v[40:43], v[52:55], v[240:247], v30
    v_and_b32 v59, 0xffff0000, v59
    v_sqrt_f32 v59, v59
    s_nop 0
    v_cvt_pk_bf16_f32 v59, v59, v59
    v_smfmac_f32_16x16x64_bf16 v[36:39], v[48:51], v[208:215], v30
    v_and_b32 v59, 0xffff0000, v59
    v_rcp_f32 v59, v59
    v_smfmac_f32_16x16x64_bf16 v[40:43], v[48:51], v[248:255], v30
    s_mov_b32 exec_lo, 0
    s_mov_b32 exec_hi, 0x80000000
    ds_write_b64 v63, v[58:59] offset:512
    s_mov_b64 exec, -1
L_gudone:
    s_nop 6
    v_permlane32_swap_b32 v36, v40
    v_permlane32_swap_b32 v37, v41
    v_permlane32_swap_b32 v38, v42
    v_permlane32_swap_b32 v39, v43
    v_add_f32_dpp v36, v40, v36 row_ror:8 row_mask:0xf bank_mask:0xf
    v_add_f32_dpp v37, v41, v37 row_ror:8 row_mask:0xf bank_mask:0xf
    v_add_f32_dpp v38, v42, v38 row_ror:8 row_mask:0xf bank_mask:0xf
    v_add_f32_dpp v39, v43, v39 row_ror:8 row_mask:0xf bank_mask:0xf
    s_mov_b32 exec_lo, 0x00ff00ff
    s_mov_b32 exec_hi, 0x00ff00ff
    ds_write_b128 v32, v[36:39] offset:20480
    s_mov_b64 exec, -1
    s_cmp_ge_u32 s3, 4
    s_waitcnt lgkmcnt(0)
    s_barrier
    s_cbranch_scc1 L_final
    ds_read_b64 v[58:59], v63 offset:512
    ds_read2st64_b32 v[64:65], v33 offset0:80 offset1:81
    ds_read2st64_b32 v[66:67], v33 offset0:82 offset1:83
    ds_read2st64_b32 v[68:69], v33 offset0:84 offset1:85
    ds_read2st64_b32 v[70:71], v33 offset0:86 offset1:87
    ds_read2st64_b32 v[72:73], v33 offset0:88 offset1:89
    ds_read2st64_b32 v[74:75], v33 offset0:90 offset1:91
    ds_read2st64_b32 v[76:77], v33 offset0:92 offset1:93
    ds_read2st64_b32 v[78:79], v33 offset0:94 offset1:95
    s_cmp_lt_u32 s3, 2
    s_waitcnt vmcnt(0) lgkmcnt(8)
    v_mul_f32 v24, v58, v24
    v_mul_f32 v25, v58, v25
    s_waitcnt lgkmcnt(6)
    v_pk_add_f32 v[64:65], v[64:65], v[66:67]
    s_waitcnt lgkmcnt(4)
    v_pk_add_f32 v[68:69], v[68:69], v[70:71]
    v_pk_add_f32 v[64:65], v[64:65], v[68:69]
    s_waitcnt lgkmcnt(2)
    v_pk_add_f32 v[72:73], v[72:73], v[74:75]
    s_waitcnt lgkmcnt(0)
    v_pk_add_f32 v[76:77], v[76:77], v[78:79]
    v_pk_add_f32 v[72:73], v[72:73], v[76:77]
    v_pk_add_f32 v[64:65], v[64:65], v[72:73]
    v_sub_f32 v64, v64, v24
    v_sub_f32 v65, v65, v25
    v_mul_f32 v64, v59, v64
    v_mul_f32 v65, v59, v65
    v_max_f32 v64, 0, v64
    v_cvt_pk_bf16_f32 v66, v64, v65
    v_lshlrev_b32 v64, 16, v66
    v_and_b32 v65, 0xffff0000, v66
    v_mul_f32 v66, v64, v65
    v_mul_f32 v67, v64, v65
    v_mul_f32 v68, v64, v65
    v_mov_b32_dpp v67, v66 row_shr:4 row_mask:0xf bank_mask:0xa
    v_mov_b32_dpp v68, v66 row_shl:4 row_mask:0xf bank_mask:0x5
    v_cvt_pk_bf16_f32 v64, v67, v68
    s_cbranch_scc1 L_down3
    s_nop 0
    v_and_b32_dpp v48, v64, v4 quad_perm:[0,0,0,0] row_mask:0xf bank_mask:0xf
    v_and_b32_dpp v49, v64, v5 quad_perm:[0,0,0,0] row_mask:0xf bank_mask:0xf
    v_and_b32_dpp v50, v64, v6 quad_perm:[0,0,0,0] row_mask:0xf bank_mask:0xf
    v_and_b32_dpp v51, v64, v7 quad_perm:[0,0,0,0] row_mask:0xf bank_mask:0xf
    v_and_b32_dpp v52, v64, v4 quad_perm:[1,1,1,1] row_mask:0xf bank_mask:0xf
    v_and_b32_dpp v53, v64, v5 quad_perm:[1,1,1,1] row_mask:0xf bank_mask:0xf
    v_smfmac_f32_16x16x64_bf16 v[44:47], v[48:51], v[112:119], v30
    v_and_b32_dpp v54, v64, v6 quad_perm:[1,1,1,1] row_mask:0xf bank_mask:0xf
    v_and_b32_dpp v55, v64, v7 quad_perm:[1,1,1,1] row_mask:0xf bank_mask:0xf
    v_smfmac_f32_16x16x64_bf16 v[16:19], v[48:51], v[144:151], v30
    s_nop 0
    v_smfmac_f32_16x16x64_bf16 v[44:47], v[52:55], v[120:127], v30
    v_and_b32_dpp v48, v64, v4 quad_perm:[2,2,2,2] row_mask:0xf bank_mask:0xf
    v_and_b32_dpp v49, v64, v5 quad_perm:[2,2,2,2] row_mask:0xf bank_mask:0xf
    v_and_b32_dpp v50, v64, v6 quad_perm:[2,2,2,2] row_mask:0xf bank_mask:0xf
    v_and_b32_dpp v51, v64, v7 quad_perm:[2,2,2,2] row_mask:0xf bank_mask:0xf
    v_smfmac_f32_16x16x64_bf16 v[16:19], v[52:55], v[152:159], v30
    s_nop 0
    v_smfmac_f32_16x16x64_bf16 v[44:47], v[48:51], v[128:135], v30
    v_and_b32_dpp v52, v64, v4 quad_perm:[3,3,3,3] row_mask:0xf bank_mask:0xf
    v_and_b32_dpp v53, v64, v5 quad_perm:[3,3,3,3] row_mask:0xf bank_mask:0xf
    v_and_b32_dpp v54, v64, v6 quad_perm:[3,3,3,3] row_mask:0xf bank_mask:0xf
    v_and_b32_dpp v55, v64, v7 quad_perm:[3,3,3,3] row_mask:0xf bank_mask:0xf
    v_smfmac_f32_16x16x64_bf16 v[16:19], v[48:51], v[160:167], v30
    s_nop 0
    v_smfmac_f32_16x16x64_bf16 v[44:47], v[52:55], v[136:143], v30
    v_smfmac_f32_16x16x64_bf16 v[16:19], v[52:55], v[168:175], v30
    s_cmp_eq_u64 s[96:97], 0
    s_cbranch_scc0 L_dnfar36
    s_nop 5
    v_permlane32_swap_b32 v44, v16
    v_permlane32_swap_b32 v45, v17
    v_permlane32_swap_b32 v46, v18
    v_permlane32_swap_b32 v47, v19
    v_add_f32_dpp v44, v16, v44 row_ror:8 row_mask:0xf bank_mask:0xf
    v_add_f32_dpp v45, v17, v45 row_ror:8 row_mask:0xf bank_mask:0xf
    v_add_f32_dpp v46, v18, v46 row_ror:8 row_mask:0xf bank_mask:0xf
    v_add_f32_dpp v47, v19, v47 row_ror:8 row_mask:0xf bank_mask:0xf
    s_mov_b32 exec_lo, 0x00ff00ff
    s_mov_b32 exec_hi, 0x00ff00ff
    buffer_store_dwordx4 v[44:47], v31, s[36:39], s58 offen
    s_mov_b64 exec, -1
    s_branch L_done
L_dnfar36:
    s_nop 5
    v_permlane32_swap_b32 v44, v16
    v_permlane32_swap_b32 v45, v17
    v_permlane32_swap_b32 v46, v18
    v_permlane32_swap_b32 v47, v19
    v_add_f32_dpp v44, v16, v44 row_ror:8 row_mask:0xf bank_mask:0xf
    v_add_f32_dpp v45, v17, v45 row_ror:8 row_mask:0xf bank_mask:0xf
    v_add_f32_dpp v46, v18, v46 row_ror:8 row_mask:0xf bank_mask:0xf
    v_add_f32_dpp v47, v19, v47 row_ror:8 row_mask:0xf bank_mask:0xf
    s_mov_b32 exec_lo, 0x00ff00ff
    s_mov_b32 exec_hi, 0x00ff00ff
    buffer_store_dwordx4 v[44:47], v31, s[36:39], s58 offen sc1
    s_mov_b64 exec, -1
    s_branch L_done
L_down3:
    s_nop 0
    v_and_b32_dpp v48, v64, v4 quad_perm:[0,0,0,0] row_mask:0xf bank_mask:0xf
    v_and_b32_dpp v49, v64, v5 quad_perm:[0,0,0,0] row_mask:0xf bank_mask:0xf
    v_and_b32_dpp v50, v64, v6 quad_perm:[0,0,0,0] row_mask:0xf bank_mask:0xf
    v_and_b32_dpp v51, v64, v7 quad_perm:[0,0,0,0] row_mask:0xf bank_mask:0xf
    v_and_b32_dpp v52, v64, v4 quad_perm:[1,1,1,1] row_mask:0xf bank_mask:0xf
    v_and_b32_dpp v53, v64, v5 quad_perm:[1,1,1,1] row_mask:0xf bank_mask:0xf
    v_smfmac_f32_16x16x64_bf16 v[20:23], v[48:51], v[80:87], v30
    v_and_b32_dpp v54, v64, v6 quad_perm:[1,1,1,1] row_mask:0xf bank_mask:0xf
    v_and_b32_dpp v55, v64, v7 quad_perm:[1,1,1,1] row_mask:0xf bank_mask:0xf
    v_smfmac_f32_16x16x64_bf16 v[44:47], v[48:51], v[112:119], v30
    v_smfmac_f32_16x16x64_bf16 v[16:19], v[48:51], v[144:151], v30
    v_smfmac_f32_16x16x64_bf16 v[20:23], v[52:55], v[88:95], v30
    v_and_b32_dpp v48, v64, v4 quad_perm:[2,2,2,2] row_mask:0xf bank_mask:0xf
    v_and_b32_dpp v49, v64, v5 quad_perm:[2,2,2,2] row_mask:0xf bank_mask:0xf
    v_and_b32_dpp v50, v64, v6 quad_perm:[2,2,2,2] row_mask:0xf bank_mask:0xf
    v_and_b32_dpp v51, v64, v7 quad_perm:[2,2,2,2] row_mask:0xf bank_mask:0xf
    v_smfmac_f32_16x16x64_bf16 v[44:47], v[52:55], v[120:127], v30
    v_smfmac_f32_16x16x64_bf16 v[16:19], v[52:55], v[152:159], v30
    v_smfmac_f32_16x16x64_bf16 v[20:23], v[48:51], v[96:103], v30
    v_and_b32_dpp v52, v64, v4 quad_perm:[3,3,3,3] row_mask:0xf bank_mask:0xf
    v_and_b32_dpp v53, v64, v5 quad_perm:[3,3,3,3] row_mask:0xf bank_mask:0xf
    v_and_b32_dpp v54, v64, v6 quad_perm:[3,3,3,3] row_mask:0xf bank_mask:0xf
    v_and_b32_dpp v55, v64, v7 quad_perm:[3,3,3,3] row_mask:0xf bank_mask:0xf
    v_smfmac_f32_16x16x64_bf16 v[44:47], v[48:51], v[128:135], v30
    v_smfmac_f32_16x16x64_bf16 v[16:19], v[48:51], v[160:167], v30
    v_smfmac_f32_16x16x64_bf16 v[20:23], v[52:55], v[104:111], v30
    v_smfmac_f32_16x16x64_bf16 v[44:47], v[52:55], v[136:143], v30
    v_smfmac_f32_16x16x64_bf16 v[16:19], v[52:55], v[168:175], v30
    s_cmp_eq_u64 s[96:97], 0
    s_cbranch_scc0 L_dnfar37
    s_nop 3
    v_permlane32_swap_b32 v20, v22
    v_permlane32_swap_b32 v21, v23
    v_permlane32_swap_b32 v44, v16
    v_permlane32_swap_b32 v45, v17
    v_permlane32_swap_b32 v46, v18
    v_permlane32_swap_b32 v47, v19
    v_add_f32_dpp v20, v22, v20 row_ror:8 row_mask:0xf bank_mask:0xf
    v_add_f32_dpp v21, v23, v21 row_ror:8 row_mask:0xf bank_mask:0xf
    v_add_f32_dpp v44, v16, v44 row_ror:8 row_mask:0xf bank_mask:0xf
    v_add_f32_dpp v45, v17, v45 row_ror:8 row_mask:0xf bank_mask:0xf
    v_add_f32_dpp v46, v18, v46 row_ror:8 row_mask:0xf bank_mask:0xf
    v_add_f32_dpp v47, v19, v47 row_ror:8 row_mask:0xf bank_mask:0xf
    s_mov_b32 exec_lo, 0x00ff00ff
    s_mov_b32 exec_hi, 0x00ff00ff
    buffer_store_dwordx2 v[20:21], v13, s[36:39], s59 offen offset:2048
    buffer_store_dwordx4 v[44:47], v31, s[36:39], s58 offen
    s_mov_b64 exec, -1
    s_branch L_done
L_dnfar37:
    s_nop 5
    v_permlane32_swap_b32 v20, v22
    v_permlane32_swap_b32 v21, v23
    v_permlane32_swap_b32 v44, v16
    v_permlane32_swap_b32 v45, v17
    v_permlane32_swap_b32 v46, v18
    v_permlane32_swap_b32 v47, v19
    v_add_f32_dpp v20, v22, v20 row_ror:8 row_mask:0xf bank_mask:0xf
    v_add_f32_dpp v21, v23, v21 row_ror:8 row_mask:0xf bank_mask:0xf
    v_add_f32_dpp v44, v16, v44 row_ror:8 row_mask:0xf bank_mask:0xf
    v_add_f32_dpp v45, v17, v45 row_ror:8 row_mask:0xf bank_mask:0xf
    v_add_f32_dpp v46, v18, v46 row_ror:8 row_mask:0xf bank_mask:0xf
    v_add_f32_dpp v47, v19, v47 row_ror:8 row_mask:0xf bank_mask:0xf
    s_mov_b32 exec_lo, 0x00ff00ff
    s_mov_b32 exec_hi, 0x00ff00ff
    buffer_store_dwordx2 v[20:21], v13, s[36:39], s59 offen offset:2048 sc1
    buffer_store_dwordx4 v[44:47], v31, s[36:39], s58 offen sc1
    s_mov_b64 exec, -1
    s_branch L_done
L_final:
    s_cmp_lg_u32 s3, 6
    s_cbranch_scc1 L_done
    s_cmp_ge_u32 s50, 20
    s_cbranch_scc1 L_done
    ds_read_u16 v20, v27 offset:576
    s_waitcnt lgkmcnt(0)
    v_lshlrev_b32 v20, 16, v20
    s_mov_b32 s94, 1048576
    buffer_load_dwordx4 v[112:115], v3, s[36:39], s60 offen sc1
    buffer_load_dwordx4 v[116:119], v3, s[36:39], s61 offen sc1
    buffer_load_dwordx4 v[120:123], v3, s[36:39], s62 offen sc1
L_pp38:
    buffer_load_dwordx4 v[124:127], v3, s[36:39], s60 offen sc1
    buffer_load_dwordx4 v[128:131], v3, s[36:39], s61 offen sc1
    buffer_load_dwordx4 v[132:135], v3, s[36:39], s62 offen sc1
    s_waitcnt vmcnt(3)
    v_max3_u32 v62, v112, v113, v114
    v_max3_u32 v62, v62, v115, v116
    v_max3_u32 v62, v62, v117, v118
    v_max3_u32 v62, v62, v119, v120
    v_max3_u32 v62, v62, v121, v122
    v_max_u32 v62, v62, v123
    v_cmp_eq_u32 vcc, -1, v62
    s_nop 1
    s_cbranch_vccz L_ppa38
    buffer_load_dwordx4 v[112:115], v3, s[36:39], s60 offen sc1
    buffer_load_dwordx4 v[116:119], v3, s[36:39], s61 offen sc1
    buffer_load_dwordx4 v[120:123], v3, s[36:39], s62 offen sc1
    s_waitcnt vmcnt(3)
    v_max3_u32 v62, v124, v125, v126
    v_max3_u32 v62, v62, v127, v128
    v_max3_u32 v62, v62, v129, v130
    v_max3_u32 v62, v62, v131, v132
    v_max3_u32 v62, v62, v133, v134
    v_max_u32 v62, v62, v135
    v_cmp_eq_u32 vcc, -1, v62
    s_nop 1
    s_cbranch_vccz L_ppb38
    s_sub_u32 s94, s94, 1
    s_cmp_lg_u32 s94, 0
    s_cbranch_scc1 L_pp38
L_ppb38:
    v_pk_add_f32 v[8:9], v[124:125], v[128:129]
    v_pk_add_f32 v[10:11], v[126:127], v[130:131]
    v_pk_add_f32 v[8:9], v[8:9], v[132:133]
    v_pk_add_f32 v[10:11], v[10:11], v[134:135]
    s_branch L_ppj38
L_ppa38:
    v_pk_add_f32 v[8:9], v[112:113], v[116:117]
    v_pk_add_f32 v[10:11], v[114:115], v[118:119]
    v_pk_add_f32 v[8:9], v[8:9], v[120:121]
    v_pk_add_f32 v[10:11], v[10:11], v[122:123]
L_ppj38:
    s_nop 1
    v_permlane32_swap_b32 v8, v10
    v_permlane32_swap_b32 v9, v11
    v_pk_add_f32 v[8:9], v[8:9], v[10:11]
    s_nop 1
    v_permlane16_swap_b32 v8, v9
    v_add_f32 v8, v8, v9
    s_nop 1
    v_add_f32_dpp v8, v8, v8 row_ror:8 row_mask:0xf bank_mask:0xf
    v_cvt_pk_bf16_f32 v8, v8, v8
    v_and_b32 v8, 0xffff0000, v8
    v_add_f32 v8, v8, v20
    v_cvt_pk_bf16_f32 v8, v8, v8
    s_mov_b32 exec_lo, 0x00ff00ff
    s_mov_b32 exec_hi, 0x00ff00ff
    buffer_store_short v8, v27, s[76:79], 0 offen
    s_mov_b64 exec, -1
L_done:
L_exit:
    s_endpgm
L_rc34:
    v_max3_u32 v62, v64, v65, v66
    v_max3_u32 v62, v62, v67, v68
    v_max3_u32 v62, v62, v69, v70
    v_max3_u32 v62, v62, v71, v72
    v_max3_u32 v62, v62, v73, v74
    v_max3_u32 v62, v62, v75, v76
    v_max3_u32 v62, v62, v77, v78
    v_max_u32 v62, v62, v79
    v_cmp_eq_u32 vcc, -1, v62
    s_nop 1
    s_cbranch_vccz L_rb34
    s_cmp_le_u32 s94, 1
    s_cbranch_scc1 L_rb34
    s_sub_u32 s94, s94, 1
    s_branch L_poll34
L_rc35:
    v_max3_u32 v62, v80, v81, v82
    v_max3_u32 v62, v62, v83, v84
    v_max3_u32 v62, v62, v85, v86
    v_max3_u32 v62, v62, v87, v88
    v_max3_u32 v62, v62, v89, v90
    v_max3_u32 v62, v62, v91, v92
    v_max3_u32 v62, v62, v93, v94
    v_max_u32 v62, v62, v95
    v_cmp_eq_u32 vcc, -1, v62
    s_nop 1
    s_cbranch_vccz L_rb35
    s_cmp_le_u32 s94, 1
    s_cbranch_scc1 L_rb35
    s_sub_u32 s94, s94, 1
    s_branch L_poll35
.fill 4096, 4, 0xbf810000
.section .rodata,"a"
.p2align 6
.amdhsa_kernel sequential_preLN__mha_block_cached__glu_gated_reglu__decode_kernel
  .amdhsa_next_free_vgpr 256
  .amdhsa_next_free_sgpr 102
  .amdhsa_accum_offset 256
  .amdhsa_group_segment_fixed_size 0
  .amdhsa_kernarg_size 96
  .amdhsa_user_sgpr_count 2
  .amdhsa_user_sgpr_kernarg_segment_ptr 1
  .amdhsa_system_sgpr_workgroup_id_x 1
.end_amdhsa_kernel
```
